```python
import torch

def _softmax(x, axis=-1):
    return torch.softmax(x, dim=axis)

def _gelu(x):
    return torch.nn.functional.gelu(x, approximate='tanh')

def _silu(x):
    return torch.nn.functional.silu(x)

def _sigmoid(x):
    return torch.sigmoid(x)

def _layernorm(x, axis=-1, eps=1e-05):
    m = x.mean(dim=axis, keepdim=True)
    v = x.var(dim=axis, keepdim=True, unbiased=False)
    return (x - m) / torch.sqrt(v + eps)

def _scatter_add(tgt, idx, src, axis=0):
    return tgt.clone().index_add_(axis, idx, src)

def _segment_sum(src, seg, n):
    out = torch.zeros((n,) + src.shape[1:], dtype=src.dtype)
    return out.index_add_(0, seg, src)

def _pad(x, pw):
    flat = tuple((v for pair in reversed(pw) for v in pair))
    return torch.nn.functional.pad(x, flat)
kernel_name = 'adaLN_cond__sliding_local_dilated__glu_gated_swiglu__prompt'

def setup_inputs():

    _w = lambda a: (lambda t: t.to(torch.bfloat16) if t.is_floating_point() else t)(torch.as_tensor(a))

    def _A_setup():
        B, S, D = (1, 2048, 512)
        return {'x': _w((lambda *s: torch.randn(*s, dtype=torch.bfloat16) * 0.05)(B, S, D)), 'wqkv': _w((lambda *s: torch.randn(*s, dtype=torch.bfloat16) * 0.1)(D, 3 * D)), 'wo': _w((lambda *s: torch.randn(*s, dtype=torch.bfloat16) * 0.1)(D, D))}
    _A_in = _A_setup()

    def _B_setup():
        B, S, D, F = (1, 2048, 512, 1376)
        return {'x': _w((lambda *s: torch.randn(*s, dtype=torch.bfloat16) * 0.05)(B, S, D)), 'w1': _w((lambda *s: torch.randn(*s, dtype=torch.bfloat16) * 1.6)(D, F) * (2.0 / D) ** 0.5), 'w3': _w((lambda *s: torch.randn(*s, dtype=torch.bfloat16) * 1.6)(D, F) * (2.0 / D) ** 0.5), 'w2': _w((lambda *s: torch.randn(*s, dtype=torch.bfloat16) * 1.6)(F, D) * (2.0 / F) ** 0.5)}
    _B_in = _B_setup()
    return {'A_x': _A_in['x'], 'A_wqkv': _A_in['wqkv'], 'A_wo': _A_in['wo'], 'B_x': _B_in['x'], 'B_w1': _B_in['w1'], 'B_w3': _B_in['w3'], 'B_w2': _B_in['w2'], 'c': _w((lambda *s: torch.randn(*s, dtype=torch.bfloat16) * 0.2)(1, 512) * 8.0), 'w_mod': _w((lambda *s: torch.randn(*s, dtype=torch.bfloat16) * 0.2)(512, 6 * 512) * 512 ** (-0.5) * 8.0)}

def reference(A_x, A_wqkv, A_wo, B_x, B_w1, B_w3, B_w2, c, w_mod):

    def _A_ref(x, wqkv, wo):
        B, S, D = x.shape
        H = 32
        Dh = D // H
        W, dil = (8, 2)
        qkv = (lambda x, *d: x.permute(*d))((x @ wqkv).reshape(B, S, 3, H, Dh), 2, 0, 3, 1, 4)
        q, k, v = (qkv[0], qkv[1], qkv[2])
        scale = Dh ** (-0.5)
        pos = torch.arange(S)
        off = torch.arange(W) * dil
        idx = pos[:, None] - off[None, :]
        mask = idx >= 0
        idx_c = torch.where(mask, idx, 0).reshape(-1)
        kg = k[:, :, idx_c, :].reshape(B, H, S, W, Dh)
        vg = v[:, :, idx_c, :].reshape(B, H, S, W, Dh)
        logits = torch.einsum('bhsd,bhswd->bhsw', q, kg) * scale
        logits = torch.where(mask[None, None, :, :], logits, -1000000000.0)
        attn = _softmax(logits, axis=-1)
        o = torch.einsum('bhsw,bhswd->bhsd', attn, vg)
        return (lambda x, *d: x.permute(*d))(o, 0, 2, 1, 3).reshape(B, S, D) @ wo

    def _B_ref(x, w1, w3, w2):
        gate = torch.einsum('bsd,df->bsf', x, w1)
        up = torch.einsum('bsd,df->bsf', x, w3)
        h = _silu(gate) * up
        out = torch.einsum('bsf,fd->bsd', h, w2)
        return out
    x = A_x
    mod = (_silu(c) @ w_mod).reshape(c.shape[0], 6, 1, -1)
    sa, ca, ga, sb, cb, gb = (mod[:, 0].clone(), mod[:, 1].clone(), mod[:, 2].clone(), mod[:, 3].clone(), mod[:, 4].clone(), mod[:, 5].clone())
    h = _layernorm(x, axis=-1) * (1 + ca) + sa
    x = x + ga * _A_ref(h, A_wqkv, A_wo)
    h = _layernorm(x, axis=-1) * (1 + cb) + sb
    x = x + gb * _B_ref(h, B_w1, B_w3, B_w2)
    return x
```

```asm
; @launch kernel=k0_kernel grid=(320,1,1) block=(256,1,1) lds=32768
; @launch kernel=km_kernel grid=(256,1,1) block=(512,1,1) lds=163840
.amdgcn_target "amdgcn-amd-amdhsa--gfx950"
.text
.globl k0_kernel
.p2align 8
.type k0_kernel,@function
k0_kernel:
  s_load_dwordx2 s[6:7], s[0:1], 88
  s_load_dwordx4 s[16:19], s[0:1], 0
  s_load_dwordx2 s[20:21], s[0:1], 16
  s_load_dwordx4 s[28:31], s[0:1], 56
  s_load_dwordx4 s[24:27], s[0:1], 32
  s_load_dwordx2 s[22:23], s[0:1], 48
  v_lshrrev_b32 v1, 6, v0
  v_and_b32 v2, 63, v0
  v_readfirstlane_b32 s3, v1
  s_mov_b32 s40, 0x05040100
  s_mov_b32 s41, 0x07060302
  s_waitcnt lgkmcnt(0)
  s_mov_b32 s8, s6
  s_and_b32 s9, s7, 0xffff
  s_mov_b32 s10, 33554432
  s_mov_b32 s11, 0x00020000
  s_cmp_lt_u32 s2, 192
  s_cbranch_scc1 K0_MOD
  s_cmp_lt_u32 s2, 256
  s_cbranch_scc1 K0_XN
  s_cmp_lt_u32 s2, 304
  s_cbranch_scc1 K0_WQ
  s_cmp_lt_u32 s2, 320
  s_cbranch_scc1 K0_WO
  s_endpgm
K0_MOD:
  s_mov_b32 s12, s30
  s_and_b32 s13, s31, 0xffff
  s_mov_b32 s14, 3145728
  s_mov_b32 s15, 0x00020000
  s_mov_b32 s52, s28
  s_and_b32 s53, s29, 0xffff
  s_mov_b32 s54, 1024
  s_mov_b32 s55, 0x00020000
  s_mov_b32 s32, 0x5555556
  s_mul_hi_u32 s33, s2, s32
  s_mul_i32 s34, s33, 48
  s_sub_u32 s34, s2, s34
  v_lshrrev_b32 v3, 3, v0
  v_and_b32 v4, 7, v0
  s_lshl_b32 s35, s33, 8
  v_lshlrev_b32 v5, 3, v3
  buffer_load_dwordx2 v[6:7], v5, s[52:55], s35 offen
  s_mul_i32 s36, s33, 786432
  s_lshl_b32 s37, s34, 7
  s_add_u32 s36, s36, s37
  s_mov_b32 s38, 24576
  v_mul_lo_u32 v8, v3, s38
  v_lshl_add_u32 v8, v4, 4, v8
  v_add_u32 v9, 6144, v8
  v_add_u32 v10, 12288, v8
  v_add_u32 v11, 18432, v8
  buffer_load_dwordx4 v[16:19], v8, s[12:15], s36 offen
  buffer_load_dwordx4 v[20:23], v9, s[12:15], s36 offen
  buffer_load_dwordx4 v[24:27], v10, s[12:15], s36 offen
  buffer_load_dwordx4 v[28:31], v11, s[12:15], s36 offen
  s_mov_b32 s39, 1069066811
  s_waitcnt vmcnt(4)
  v_lshlrev_b32 v12, 16, v6
  v_and_b32 v13, 0xffff0000, v6
  v_lshlrev_b32 v14, 16, v7
  v_and_b32 v15, 0xffff0000, v7
  v_mul_f32 v32, s39, v12
  v_exp_f32 v32, -v32
  s_nop 0
  v_add_f32 v32, 1.0, v32
  v_rcp_f32 v32, v32
  s_nop 0
  v_mul_f32 v12, v12, v32
  v_cvt_pk_bf16_f32 v12, v12, v12
  v_lshlrev_b32 v12, 16, v12
  v_mul_f32 v32, s39, v13
  v_exp_f32 v32, -v32
  s_nop 0
  v_add_f32 v32, 1.0, v32
  v_rcp_f32 v32, v32
  s_nop 0
  v_mul_f32 v13, v13, v32
  v_cvt_pk_bf16_f32 v13, v13, v13
  v_lshlrev_b32 v13, 16, v13
  v_mul_f32 v32, s39, v14
  v_exp_f32 v32, -v32
  s_nop 0
  v_add_f32 v32, 1.0, v32
  v_rcp_f32 v32, v32
  s_nop 0
  v_mul_f32 v14, v14, v32
  v_cvt_pk_bf16_f32 v14, v14, v14
  v_lshlrev_b32 v14, 16, v14
  v_mul_f32 v32, s39, v15
  v_exp_f32 v32, -v32
  s_nop 0
  v_add_f32 v32, 1.0, v32
  v_rcp_f32 v32, v32
  s_nop 0
  v_mul_f32 v15, v15, v32
  v_cvt_pk_bf16_f32 v15, v15, v15
  v_lshlrev_b32 v15, 16, v15
  s_waitcnt vmcnt(0)
  v_lshlrev_b32 v33, 16, v16
  v_and_b32 v34, 0xffff0000, v16
  v_mul_f32 v40, v12, v33
  v_mul_f32 v41, v12, v34
  v_lshlrev_b32 v33, 16, v17
  v_and_b32 v34, 0xffff0000, v17
  v_mul_f32 v42, v12, v33
  v_mul_f32 v43, v12, v34
  v_lshlrev_b32 v33, 16, v18
  v_and_b32 v34, 0xffff0000, v18
  v_mul_f32 v44, v12, v33
  v_mul_f32 v45, v12, v34
  v_lshlrev_b32 v33, 16, v19
  v_and_b32 v34, 0xffff0000, v19
  v_mul_f32 v46, v12, v33
  v_mul_f32 v47, v12, v34
  v_lshlrev_b32 v33, 16, v20
  v_and_b32 v34, 0xffff0000, v20
  v_fmac_f32 v40, v13, v33
  v_fmac_f32 v41, v13, v34
  v_lshlrev_b32 v33, 16, v21
  v_and_b32 v34, 0xffff0000, v21
  v_fmac_f32 v42, v13, v33
  v_fmac_f32 v43, v13, v34
  v_lshlrev_b32 v33, 16, v22
  v_and_b32 v34, 0xffff0000, v22
  v_fmac_f32 v44, v13, v33
  v_fmac_f32 v45, v13, v34
  v_lshlrev_b32 v33, 16, v23
  v_and_b32 v34, 0xffff0000, v23
  v_fmac_f32 v46, v13, v33
  v_fmac_f32 v47, v13, v34
  v_lshlrev_b32 v33, 16, v24
  v_and_b32 v34, 0xffff0000, v24
  v_fmac_f32 v40, v14, v33
  v_fmac_f32 v41, v14, v34
  v_lshlrev_b32 v33, 16, v25
  v_and_b32 v34, 0xffff0000, v25
  v_fmac_f32 v42, v14, v33
  v_fmac_f32 v43, v14, v34
  v_lshlrev_b32 v33, 16, v26
  v_and_b32 v34, 0xffff0000, v26
  v_fmac_f32 v44, v14, v33
  v_fmac_f32 v45, v14, v34
  v_lshlrev_b32 v33, 16, v27
  v_and_b32 v34, 0xffff0000, v27
  v_fmac_f32 v46, v14, v33
  v_fmac_f32 v47, v14, v34
  v_lshlrev_b32 v33, 16, v28
  v_and_b32 v34, 0xffff0000, v28
  v_fmac_f32 v40, v15, v33
  v_fmac_f32 v41, v15, v34
  v_lshlrev_b32 v33, 16, v29
  v_and_b32 v34, 0xffff0000, v29
  v_fmac_f32 v42, v15, v33
  v_fmac_f32 v43, v15, v34
  v_lshlrev_b32 v33, 16, v30
  v_and_b32 v34, 0xffff0000, v30
  v_fmac_f32 v44, v15, v33
  v_fmac_f32 v45, v15, v34
  v_lshlrev_b32 v33, 16, v31
  v_and_b32 v34, 0xffff0000, v31
  v_fmac_f32 v46, v15, v33
  v_fmac_f32 v47, v15, v34
  v_lshlrev_b32 v5, 5, v0
  ds_write_b128 v5, v[40:43]
  ds_write_b128 v5, v[44:47] offset:16
  s_waitcnt lgkmcnt(0)
  s_barrier
  s_cmp_lg_u32 s3, 0
  s_cbranch_scc1 K0_END
  v_lshlrev_b32 v5, 2, v0
  ds_read_b32 v16, v5 offset:0
  ds_read_b32 v17, v5 offset:256
  ds_read_b32 v18, v5 offset:512
  ds_read_b32 v19, v5 offset:768
  ds_read_b32 v20, v5 offset:1024
  ds_read_b32 v21, v5 offset:1280
  ds_read_b32 v22, v5 offset:1536
  ds_read_b32 v23, v5 offset:1792
  ds_read_b32 v24, v5 offset:2048
  ds_read_b32 v25, v5 offset:2304
  ds_read_b32 v26, v5 offset:2560
  ds_read_b32 v27, v5 offset:2816
  ds_read_b32 v28, v5 offset:3072
  ds_read_b32 v29, v5 offset:3328
  ds_read_b32 v30, v5 offset:3584
  ds_read_b32 v31, v5 offset:3840
  ds_read_b32 v32, v5 offset:4096
  ds_read_b32 v33, v5 offset:4352
  ds_read_b32 v34, v5 offset:4608
  ds_read_b32 v35, v5 offset:4864
  ds_read_b32 v36, v5 offset:5120
  ds_read_b32 v37, v5 offset:5376
  ds_read_b32 v38, v5 offset:5632
  ds_read_b32 v39, v5 offset:5888
  ds_read_b32 v40, v5 offset:6144
  ds_read_b32 v41, v5 offset:6400
  ds_read_b32 v42, v5 offset:6656
  ds_read_b32 v43, v5 offset:6912
  ds_read_b32 v44, v5 offset:7168
  ds_read_b32 v45, v5 offset:7424
  ds_read_b32 v46, v5 offset:7680
  ds_read_b32 v47, v5 offset:7936
  s_waitcnt lgkmcnt(0)
  v_add_f32 v16, v16, v32
  v_add_f32 v17, v17, v33
  v_add_f32 v18, v18, v34
  v_add_f32 v19, v19, v35
  v_add_f32 v20, v20, v36
  v_add_f32 v21, v21, v37
  v_add_f32 v22, v22, v38
  v_add_f32 v23, v23, v39
  v_add_f32 v24, v24, v40
  v_add_f32 v25, v25, v41
  v_add_f32 v26, v26, v42
  v_add_f32 v27, v27, v43
  v_add_f32 v28, v28, v44
  v_add_f32 v29, v29, v45
  v_add_f32 v30, v30, v46
  v_add_f32 v31, v31, v47
  v_add_f32 v16, v16, v24
  v_add_f32 v17, v17, v25
  v_add_f32 v18, v18, v26
  v_add_f32 v19, v19, v27
  v_add_f32 v20, v20, v28
  v_add_f32 v21, v21, v29
  v_add_f32 v22, v22, v30
  v_add_f32 v23, v23, v31
  v_add_f32 v16, v16, v20
  v_add_f32 v17, v17, v21
  v_add_f32 v18, v18, v22
  v_add_f32 v19, v19, v23
  v_add_f32 v16, v16, v18
  v_add_f32 v17, v17, v19
  v_add_f32 v16, v16, v17
  s_mul_i32 s36, s33, 12288
  s_lshl_b32 s37, s34, 8
  s_add_u32 s36, s36, s37
  buffer_store_dword v16, v5, s[8:11], s36 offen
  s_endpgm
K0_XN:
  s_mov_b32 s12, s16
  s_and_b32 s13, s17, 0xffff
  s_mov_b32 s14, 2097152
  s_mov_b32 s15, 0x00020000
  s_sub_u32 s33, s2, 192
  v_lshlrev_b32 v3, 2, v0
  v_mov_b32 v4, 0
  s_lshl_b32 s34, s33, 10
  s_add_u32 s34, s34, 196608
  buffer_store_dword v4, v3, s[8:11], s34 offen
  v_and_b32 v3, 31, v2
  v_lshrrev_b32 v4, 5, v2
  v_lshlrev_b32 v5, 10, v3
  v_lshl_add_u32 v5, v4, 7, v5
  s_lshl_b32 s34, s33, 15
  s_lshl_b32 s35, s3, 8
  s_add_u32 s34, s34, s35
  buffer_load_dwordx4 v[16:19], v5, s[12:15], s34 offen offset:0
  buffer_load_dwordx4 v[20:23], v5, s[12:15], s34 offen offset:16
  buffer_load_dwordx4 v[24:27], v5, s[12:15], s34 offen offset:32
  buffer_load_dwordx4 v[28:31], v5, s[12:15], s34 offen offset:48
  buffer_load_dwordx4 v[32:35], v5, s[12:15], s34 offen offset:64
  buffer_load_dwordx4 v[36:39], v5, s[12:15], s34 offen offset:80
  buffer_load_dwordx4 v[40:43], v5, s[12:15], s34 offen offset:96
  buffer_load_dwordx4 v[44:47], v5, s[12:15], s34 offen offset:112
  s_waitcnt vmcnt(0)
  v_lshlrev_b32 v64, 16, v16
  v_and_b32 v65, 0xffff0000, v16
  v_lshlrev_b32 v66, 16, v17
  v_and_b32 v67, 0xffff0000, v17
  v_lshlrev_b32 v68, 16, v18
  v_and_b32 v69, 0xffff0000, v18
  v_lshlrev_b32 v70, 16, v19
  v_and_b32 v71, 0xffff0000, v19
  v_lshlrev_b32 v72, 16, v20
  v_and_b32 v73, 0xffff0000, v20
  v_lshlrev_b32 v74, 16, v21
  v_and_b32 v75, 0xffff0000, v21
  v_lshlrev_b32 v76, 16, v22
  v_and_b32 v77, 0xffff0000, v22
  v_lshlrev_b32 v78, 16, v23
  v_and_b32 v79, 0xffff0000, v23
  v_lshlrev_b32 v80, 16, v24
  v_and_b32 v81, 0xffff0000, v24
  v_lshlrev_b32 v82, 16, v25
  v_and_b32 v83, 0xffff0000, v25
  v_lshlrev_b32 v84, 16, v26
  v_and_b32 v85, 0xffff0000, v26
  v_lshlrev_b32 v86, 16, v27
  v_and_b32 v87, 0xffff0000, v27
  v_lshlrev_b32 v88, 16, v28
  v_and_b32 v89, 0xffff0000, v28
  v_lshlrev_b32 v90, 16, v29
  v_and_b32 v91, 0xffff0000, v29
  v_lshlrev_b32 v92, 16, v30
  v_and_b32 v93, 0xffff0000, v30
  v_lshlrev_b32 v94, 16, v31
  v_and_b32 v95, 0xffff0000, v31
  v_lshlrev_b32 v96, 16, v32
  v_and_b32 v97, 0xffff0000, v32
  v_lshlrev_b32 v98, 16, v33
  v_and_b32 v99, 0xffff0000, v33
  v_lshlrev_b32 v100, 16, v34
  v_and_b32 v101, 0xffff0000, v34
  v_lshlrev_b32 v102, 16, v35
  v_and_b32 v103, 0xffff0000, v35
  v_lshlrev_b32 v104, 16, v36
  v_and_b32 v105, 0xffff0000, v36
  v_lshlrev_b32 v106, 16, v37
  v_and_b32 v107, 0xffff0000, v37
  v_lshlrev_b32 v108, 16, v38
  v_and_b32 v109, 0xffff0000, v38
  v_lshlrev_b32 v110, 16, v39
  v_and_b32 v111, 0xffff0000, v39
  v_lshlrev_b32 v112, 16, v40
  v_and_b32 v113, 0xffff0000, v40
  v_lshlrev_b32 v114, 16, v41
  v_and_b32 v115, 0xffff0000, v41
  v_lshlrev_b32 v116, 16, v42
  v_and_b32 v117, 0xffff0000, v42
  v_lshlrev_b32 v118, 16, v43
  v_and_b32 v119, 0xffff0000, v43
  v_lshlrev_b32 v120, 16, v44
  v_and_b32 v121, 0xffff0000, v44
  v_lshlrev_b32 v122, 16, v45
  v_and_b32 v123, 0xffff0000, v45
  v_lshlrev_b32 v124, 16, v46
  v_and_b32 v125, 0xffff0000, v46
  v_lshlrev_b32 v126, 16, v47
  v_and_b32 v127, 0xffff0000, v47
  v_add_f32 v10, v64, v68
  v_add_f32 v11, v65, v69
  v_add_f32 v12, v66, v70
  v_add_f32 v13, v67, v71
  v_add_f32 v10, v10, v72
  v_add_f32 v11, v11, v73
  v_add_f32 v12, v12, v74
  v_add_f32 v13, v13, v75
  v_add_f32 v10, v10, v76
  v_add_f32 v11, v11, v77
  v_add_f32 v12, v12, v78
  v_add_f32 v13, v13, v79
  v_add_f32 v10, v10, v80
  v_add_f32 v11, v11, v81
  v_add_f32 v12, v12, v82
  v_add_f32 v13, v13, v83
  v_add_f32 v10, v10, v84
  v_add_f32 v11, v11, v85
  v_add_f32 v12, v12, v86
  v_add_f32 v13, v13, v87
  v_add_f32 v10, v10, v88
  v_add_f32 v11, v11, v89
  v_add_f32 v12, v12, v90
  v_add_f32 v13, v13, v91
  v_add_f32 v10, v10, v92
  v_add_f32 v11, v11, v93
  v_add_f32 v12, v12, v94
  v_add_f32 v13, v13, v95
  v_add_f32 v10, v10, v96
  v_add_f32 v11, v11, v97
  v_add_f32 v12, v12, v98
  v_add_f32 v13, v13, v99
  v_add_f32 v10, v10, v100
  v_add_f32 v11, v11, v101
  v_add_f32 v12, v12, v102
  v_add_f32 v13, v13, v103
  v_add_f32 v10, v10, v104
  v_add_f32 v11, v11, v105
  v_add_f32 v12, v12, v106
  v_add_f32 v13, v13, v107
  v_add_f32 v10, v10, v108
  v_add_f32 v11, v11, v109
  v_add_f32 v12, v12, v110
  v_add_f32 v13, v13, v111
  v_add_f32 v10, v10, v112
  v_add_f32 v11, v11, v113
  v_add_f32 v12, v12, v114
  v_add_f32 v13, v13, v115
  v_add_f32 v10, v10, v116
  v_add_f32 v11, v11, v117
  v_add_f32 v12, v12, v118
  v_add_f32 v13, v13, v119
  v_add_f32 v10, v10, v120
  v_add_f32 v11, v11, v121
  v_add_f32 v12, v12, v122
  v_add_f32 v13, v13, v123
  v_add_f32 v10, v10, v124
  v_add_f32 v11, v11, v125
  v_add_f32 v12, v12, v126
  v_add_f32 v13, v13, v127
  v_add_f32 v10, v10, v11
  v_add_f32 v12, v12, v13
  v_add_f32 v6, v10, v12
  v_mov_b32 v7, v6
  s_nop 1
  v_permlane32_swap_b32 v6, v7
  v_add_f32 v6, v6, v7
  v_lshlrev_b32 v8, 2, v3
  s_lshl_b32 s35, s3, 7
  v_add_u32 v9, s35, v8
  ds_write_b32 v9, v6
  s_waitcnt lgkmcnt(0)
  s_barrier
  ds_read_b32 v10, v8
  ds_read_b32 v11, v8 offset:128
  ds_read_b32 v12, v8 offset:256
  ds_read_b32 v13, v8 offset:384
  s_waitcnt lgkmcnt(0)
  v_add_f32 v10, v10, v11
  v_add_f32 v12, v12, v13
  v_add_f32 v10, v10, v12
  v_mul_f32 v14, 0x3b000000, v10
  v_sub_f32 v7, v64, v14
  v_mul_f32 v10, v7, v7
  v_sub_f32 v7, v65, v14
  v_mul_f32 v11, v7, v7
  v_sub_f32 v7, v66, v14
  v_mul_f32 v12, v7, v7
  v_sub_f32 v7, v67, v14
  v_mul_f32 v13, v7, v7
  v_sub_f32 v7, v68, v14
  v_fmac_f32 v10, v7, v7
  v_sub_f32 v7, v69, v14
  v_fmac_f32 v11, v7, v7
  v_sub_f32 v7, v70, v14
  v_fmac_f32 v12, v7, v7
  v_sub_f32 v7, v71, v14
  v_fmac_f32 v13, v7, v7
  v_sub_f32 v7, v72, v14
  v_fmac_f32 v10, v7, v7
  v_sub_f32 v7, v73, v14
  v_fmac_f32 v11, v7, v7
  v_sub_f32 v7, v74, v14
  v_fmac_f32 v12, v7, v7
  v_sub_f32 v7, v75, v14
  v_fmac_f32 v13, v7, v7
  v_sub_f32 v7, v76, v14
  v_fmac_f32 v10, v7, v7
  v_sub_f32 v7, v77, v14
  v_fmac_f32 v11, v7, v7
  v_sub_f32 v7, v78, v14
  v_fmac_f32 v12, v7, v7
  v_sub_f32 v7, v79, v14
  v_fmac_f32 v13, v7, v7
  v_sub_f32 v7, v80, v14
  v_fmac_f32 v10, v7, v7
  v_sub_f32 v7, v81, v14
  v_fmac_f32 v11, v7, v7
  v_sub_f32 v7, v82, v14
  v_fmac_f32 v12, v7, v7
  v_sub_f32 v7, v83, v14
  v_fmac_f32 v13, v7, v7
  v_sub_f32 v7, v84, v14
  v_fmac_f32 v10, v7, v7
  v_sub_f32 v7, v85, v14
  v_fmac_f32 v11, v7, v7
  v_sub_f32 v7, v86, v14
  v_fmac_f32 v12, v7, v7
  v_sub_f32 v7, v87, v14
  v_fmac_f32 v13, v7, v7
  v_sub_f32 v7, v88, v14
  v_fmac_f32 v10, v7, v7
  v_sub_f32 v7, v89, v14
  v_fmac_f32 v11, v7, v7
  v_sub_f32 v7, v90, v14
  v_fmac_f32 v12, v7, v7
  v_sub_f32 v7, v91, v14
  v_fmac_f32 v13, v7, v7
  v_sub_f32 v7, v92, v14
  v_fmac_f32 v10, v7, v7
  v_sub_f32 v7, v93, v14
  v_fmac_f32 v11, v7, v7
  v_sub_f32 v7, v94, v14
  v_fmac_f32 v12, v7, v7
  v_sub_f32 v7, v95, v14
  v_fmac_f32 v13, v7, v7
  v_sub_f32 v7, v96, v14
  v_fmac_f32 v10, v7, v7
  v_sub_f32 v7, v97, v14
  v_fmac_f32 v11, v7, v7
  v_sub_f32 v7, v98, v14
  v_fmac_f32 v12, v7, v7
  v_sub_f32 v7, v99, v14
  v_fmac_f32 v13, v7, v7
  v_sub_f32 v7, v100, v14
  v_fmac_f32 v10, v7, v7
  v_sub_f32 v7, v101, v14
  v_fmac_f32 v11, v7, v7
  v_sub_f32 v7, v102, v14
  v_fmac_f32 v12, v7, v7
  v_sub_f32 v7, v103, v14
  v_fmac_f32 v13, v7, v7
  v_sub_f32 v7, v104, v14
  v_fmac_f32 v10, v7, v7
  v_sub_f32 v7, v105, v14
  v_fmac_f32 v11, v7, v7
  v_sub_f32 v7, v106, v14
  v_fmac_f32 v12, v7, v7
  v_sub_f32 v7, v107, v14
  v_fmac_f32 v13, v7, v7
  v_sub_f32 v7, v108, v14
  v_fmac_f32 v10, v7, v7
  v_sub_f32 v7, v109, v14
  v_fmac_f32 v11, v7, v7
  v_sub_f32 v7, v110, v14
  v_fmac_f32 v12, v7, v7
  v_sub_f32 v7, v111, v14
  v_fmac_f32 v13, v7, v7
  v_sub_f32 v7, v112, v14
  v_fmac_f32 v10, v7, v7
  v_sub_f32 v7, v113, v14
  v_fmac_f32 v11, v7, v7
  v_sub_f32 v7, v114, v14
  v_fmac_f32 v12, v7, v7
  v_sub_f32 v7, v115, v14
  v_fmac_f32 v13, v7, v7
  v_sub_f32 v7, v116, v14
  v_fmac_f32 v10, v7, v7
  v_sub_f32 v7, v117, v14
  v_fmac_f32 v11, v7, v7
  v_sub_f32 v7, v118, v14
  v_fmac_f32 v12, v7, v7
  v_sub_f32 v7, v119, v14
  v_fmac_f32 v13, v7, v7
  v_sub_f32 v7, v120, v14
  v_fmac_f32 v10, v7, v7
  v_sub_f32 v7, v121, v14
  v_fmac_f32 v11, v7, v7
  v_sub_f32 v7, v122, v14
  v_fmac_f32 v12, v7, v7
  v_sub_f32 v7, v123, v14
  v_fmac_f32 v13, v7, v7
  v_sub_f32 v7, v124, v14
  v_fmac_f32 v10, v7, v7
  v_sub_f32 v7, v125, v14
  v_fmac_f32 v11, v7, v7
  v_sub_f32 v7, v126, v14
  v_fmac_f32 v12, v7, v7
  v_sub_f32 v7, v127, v14
  v_fmac_f32 v13, v7, v7
  v_add_f32 v10, v10, v11
  v_add_f32 v12, v12, v13
  v_add_f32 v6, v10, v12
  v_mov_b32 v7, v6
  s_nop 1
  v_permlane32_swap_b32 v6, v7
  v_add_f32 v6, v6, v7
  ds_write_b32 v9, v6 offset:512
  s_waitcnt lgkmcnt(0)
  s_barrier
  ds_read_b32 v10, v8 offset:512
  ds_read_b32 v11, v8 offset:640
  ds_read_b32 v12, v8 offset:768
  ds_read_b32 v13, v8 offset:896
  s_waitcnt lgkmcnt(0)
  v_add_f32 v10, v10, v11
  v_add_f32 v12, v12, v13
  v_add_f32 v10, v10, v12
  v_mul_f32 v15, 0x3b000000, v10
  v_cvt_pk_bf16_f32 v14, v14, v14
  v_lshlrev_b32 v14, 16, v14
  v_cvt_pk_bf16_f32 v15, v15, v15
  v_lshlrev_b32 v15, 16, v15
  v_add_f32 v15, 0x3727c5ac, v15
  v_cvt_pk_bf16_f32 v15, v15, v15
  v_lshlrev_b32 v15, 16, v15
  v_sqrt_f32 v15, v15
  s_nop 0
  v_cvt_pk_bf16_f32 v15, v15, v15
  v_lshlrev_b32 v15, 16, v15
  v_rcp_f32 v15, v15
  v_lshlrev_b32 v8, 4, v2
  s_lshl_b32 s34, s33, 15
  s_lshl_b32 s35, s3, 13
  s_add_u32 s34, s34, s35
  s_add_u32 s34, s34, 1048576
  v_sub_f32 v64, v64, v14
  v_sub_f32 v65, v65, v14
  v_cvt_pk_bf16_f32 v6, v64, v65
  v_lshlrev_b32 v64, 16, v6
  v_and_b32 v65, 0xffff0000, v6
  v_mul_f32 v64, v64, v15
  v_mul_f32 v65, v65, v15
  v_cvt_pk_bf16_f32 v16, v64, v65
  v_sub_f32 v66, v66, v14
  v_sub_f32 v67, v67, v14
  v_cvt_pk_bf16_f32 v6, v66, v67
  v_lshlrev_b32 v66, 16, v6
  v_and_b32 v67, 0xffff0000, v6
  v_mul_f32 v66, v66, v15
  v_mul_f32 v67, v67, v15
  v_cvt_pk_bf16_f32 v17, v66, v67
  v_sub_f32 v68, v68, v14
  v_sub_f32 v69, v69, v14
  v_cvt_pk_bf16_f32 v6, v68, v69
  v_lshlrev_b32 v68, 16, v6
  v_and_b32 v69, 0xffff0000, v6
  v_mul_f32 v68, v68, v15
  v_mul_f32 v69, v69, v15
  v_cvt_pk_bf16_f32 v18, v68, v69
  v_sub_f32 v70, v70, v14
  v_sub_f32 v71, v71, v14
  v_cvt_pk_bf16_f32 v6, v70, v71
  v_lshlrev_b32 v70, 16, v6
  v_and_b32 v71, 0xffff0000, v6
  v_mul_f32 v70, v70, v15
  v_mul_f32 v71, v71, v15
  v_cvt_pk_bf16_f32 v19, v70, v71
  buffer_store_dwordx4 v[16:19], v8, s[8:11], s34 offen offset:0
  v_sub_f32 v72, v72, v14
  v_sub_f32 v73, v73, v14
  v_cvt_pk_bf16_f32 v6, v72, v73
  v_lshlrev_b32 v72, 16, v6
  v_and_b32 v73, 0xffff0000, v6
  v_mul_f32 v72, v72, v15
  v_mul_f32 v73, v73, v15
  v_cvt_pk_bf16_f32 v20, v72, v73
  v_sub_f32 v74, v74, v14
  v_sub_f32 v75, v75, v14
  v_cvt_pk_bf16_f32 v6, v74, v75
  v_lshlrev_b32 v74, 16, v6
  v_and_b32 v75, 0xffff0000, v6
  v_mul_f32 v74, v74, v15
  v_mul_f32 v75, v75, v15
  v_cvt_pk_bf16_f32 v21, v74, v75
  v_sub_f32 v76, v76, v14
  v_sub_f32 v77, v77, v14
  v_cvt_pk_bf16_f32 v6, v76, v77
  v_lshlrev_b32 v76, 16, v6
  v_and_b32 v77, 0xffff0000, v6
  v_mul_f32 v76, v76, v15
  v_mul_f32 v77, v77, v15
  v_cvt_pk_bf16_f32 v22, v76, v77
  v_sub_f32 v78, v78, v14
  v_sub_f32 v79, v79, v14
  v_cvt_pk_bf16_f32 v6, v78, v79
  v_lshlrev_b32 v78, 16, v6
  v_and_b32 v79, 0xffff0000, v6
  v_mul_f32 v78, v78, v15
  v_mul_f32 v79, v79, v15
  v_cvt_pk_bf16_f32 v23, v78, v79
  buffer_store_dwordx4 v[20:23], v8, s[8:11], s34 offen offset:1024
  v_sub_f32 v80, v80, v14
  v_sub_f32 v81, v81, v14
  v_cvt_pk_bf16_f32 v6, v80, v81
  v_lshlrev_b32 v80, 16, v6
  v_and_b32 v81, 0xffff0000, v6
  v_mul_f32 v80, v80, v15
  v_mul_f32 v81, v81, v15
  v_cvt_pk_bf16_f32 v24, v80, v81
  v_sub_f32 v82, v82, v14
  v_sub_f32 v83, v83, v14
  v_cvt_pk_bf16_f32 v6, v82, v83
  v_lshlrev_b32 v82, 16, v6
  v_and_b32 v83, 0xffff0000, v6
  v_mul_f32 v82, v82, v15
  v_mul_f32 v83, v83, v15
  v_cvt_pk_bf16_f32 v25, v82, v83
  v_sub_f32 v84, v84, v14
  v_sub_f32 v85, v85, v14
  v_cvt_pk_bf16_f32 v6, v84, v85
  v_lshlrev_b32 v84, 16, v6
  v_and_b32 v85, 0xffff0000, v6
  v_mul_f32 v84, v84, v15
  v_mul_f32 v85, v85, v15
  v_cvt_pk_bf16_f32 v26, v84, v85
  v_sub_f32 v86, v86, v14
  v_sub_f32 v87, v87, v14
  v_cvt_pk_bf16_f32 v6, v86, v87
  v_lshlrev_b32 v86, 16, v6
  v_and_b32 v87, 0xffff0000, v6
  v_mul_f32 v86, v86, v15
  v_mul_f32 v87, v87, v15
  v_cvt_pk_bf16_f32 v27, v86, v87
  buffer_store_dwordx4 v[24:27], v8, s[8:11], s34 offen offset:2048
  v_sub_f32 v88, v88, v14
  v_sub_f32 v89, v89, v14
  v_cvt_pk_bf16_f32 v6, v88, v89
  v_lshlrev_b32 v88, 16, v6
  v_and_b32 v89, 0xffff0000, v6
  v_mul_f32 v88, v88, v15
  v_mul_f32 v89, v89, v15
  v_cvt_pk_bf16_f32 v28, v88, v89
  v_sub_f32 v90, v90, v14
  v_sub_f32 v91, v91, v14
  v_cvt_pk_bf16_f32 v6, v90, v91
  v_lshlrev_b32 v90, 16, v6
  v_and_b32 v91, 0xffff0000, v6
  v_mul_f32 v90, v90, v15
  v_mul_f32 v91, v91, v15
  v_cvt_pk_bf16_f32 v29, v90, v91
  v_sub_f32 v92, v92, v14
  v_sub_f32 v93, v93, v14
  v_cvt_pk_bf16_f32 v6, v92, v93
  v_lshlrev_b32 v92, 16, v6
  v_and_b32 v93, 0xffff0000, v6
  v_mul_f32 v92, v92, v15
  v_mul_f32 v93, v93, v15
  v_cvt_pk_bf16_f32 v30, v92, v93
  v_sub_f32 v94, v94, v14
  v_sub_f32 v95, v95, v14
  v_cvt_pk_bf16_f32 v6, v94, v95
  v_lshlrev_b32 v94, 16, v6
  v_and_b32 v95, 0xffff0000, v6
  v_mul_f32 v94, v94, v15
  v_mul_f32 v95, v95, v15
  v_cvt_pk_bf16_f32 v31, v94, v95
  buffer_store_dwordx4 v[28:31], v8, s[8:11], s34 offen offset:3072
  v_sub_f32 v96, v96, v14
  v_sub_f32 v97, v97, v14
  v_cvt_pk_bf16_f32 v6, v96, v97
  v_lshlrev_b32 v96, 16, v6
  v_and_b32 v97, 0xffff0000, v6
  v_mul_f32 v96, v96, v15
  v_mul_f32 v97, v97, v15
  v_cvt_pk_bf16_f32 v32, v96, v97
  v_sub_f32 v98, v98, v14
  v_sub_f32 v99, v99, v14
  v_cvt_pk_bf16_f32 v6, v98, v99
  v_lshlrev_b32 v98, 16, v6
  v_and_b32 v99, 0xffff0000, v6
  v_mul_f32 v98, v98, v15
  v_mul_f32 v99, v99, v15
  v_cvt_pk_bf16_f32 v33, v98, v99
  v_sub_f32 v100, v100, v14
  v_sub_f32 v101, v101, v14
  v_cvt_pk_bf16_f32 v6, v100, v101
  v_lshlrev_b32 v100, 16, v6
  v_and_b32 v101, 0xffff0000, v6
  v_mul_f32 v100, v100, v15
  v_mul_f32 v101, v101, v15
  v_cvt_pk_bf16_f32 v34, v100, v101
  v_sub_f32 v102, v102, v14
  v_sub_f32 v103, v103, v14
  v_cvt_pk_bf16_f32 v6, v102, v103
  v_lshlrev_b32 v102, 16, v6
  v_and_b32 v103, 0xffff0000, v6
  v_mul_f32 v102, v102, v15
  v_mul_f32 v103, v103, v15
  v_cvt_pk_bf16_f32 v35, v102, v103
  s_add_u32 s34, s34, 4096
  buffer_store_dwordx4 v[32:35], v8, s[8:11], s34 offen offset:0
  v_sub_f32 v104, v104, v14
  v_sub_f32 v105, v105, v14
  v_cvt_pk_bf16_f32 v6, v104, v105
  v_lshlrev_b32 v104, 16, v6
  v_and_b32 v105, 0xffff0000, v6
  v_mul_f32 v104, v104, v15
  v_mul_f32 v105, v105, v15
  v_cvt_pk_bf16_f32 v36, v104, v105
  v_sub_f32 v106, v106, v14
  v_sub_f32 v107, v107, v14
  v_cvt_pk_bf16_f32 v6, v106, v107
  v_lshlrev_b32 v106, 16, v6
  v_and_b32 v107, 0xffff0000, v6
  v_mul_f32 v106, v106, v15
  v_mul_f32 v107, v107, v15
  v_cvt_pk_bf16_f32 v37, v106, v107
  v_sub_f32 v108, v108, v14
  v_sub_f32 v109, v109, v14
  v_cvt_pk_bf16_f32 v6, v108, v109
  v_lshlrev_b32 v108, 16, v6
  v_and_b32 v109, 0xffff0000, v6
  v_mul_f32 v108, v108, v15
  v_mul_f32 v109, v109, v15
  v_cvt_pk_bf16_f32 v38, v108, v109
  v_sub_f32 v110, v110, v14
  v_sub_f32 v111, v111, v14
  v_cvt_pk_bf16_f32 v6, v110, v111
  v_lshlrev_b32 v110, 16, v6
  v_and_b32 v111, 0xffff0000, v6
  v_mul_f32 v110, v110, v15
  v_mul_f32 v111, v111, v15
  v_cvt_pk_bf16_f32 v39, v110, v111
  buffer_store_dwordx4 v[36:39], v8, s[8:11], s34 offen offset:1024
  v_sub_f32 v112, v112, v14
  v_sub_f32 v113, v113, v14
  v_cvt_pk_bf16_f32 v6, v112, v113
  v_lshlrev_b32 v112, 16, v6
  v_and_b32 v113, 0xffff0000, v6
  v_mul_f32 v112, v112, v15
  v_mul_f32 v113, v113, v15
  v_cvt_pk_bf16_f32 v40, v112, v113
  v_sub_f32 v114, v114, v14
  v_sub_f32 v115, v115, v14
  v_cvt_pk_bf16_f32 v6, v114, v115
  v_lshlrev_b32 v114, 16, v6
  v_and_b32 v115, 0xffff0000, v6
  v_mul_f32 v114, v114, v15
  v_mul_f32 v115, v115, v15
  v_cvt_pk_bf16_f32 v41, v114, v115
  v_sub_f32 v116, v116, v14
  v_sub_f32 v117, v117, v14
  v_cvt_pk_bf16_f32 v6, v116, v117
  v_lshlrev_b32 v116, 16, v6
  v_and_b32 v117, 0xffff0000, v6
  v_mul_f32 v116, v116, v15
  v_mul_f32 v117, v117, v15
  v_cvt_pk_bf16_f32 v42, v116, v117
  v_sub_f32 v118, v118, v14
  v_sub_f32 v119, v119, v14
  v_cvt_pk_bf16_f32 v6, v118, v119
  v_lshlrev_b32 v118, 16, v6
  v_and_b32 v119, 0xffff0000, v6
  v_mul_f32 v118, v118, v15
  v_mul_f32 v119, v119, v15
  v_cvt_pk_bf16_f32 v43, v118, v119
  buffer_store_dwordx4 v[40:43], v8, s[8:11], s34 offen offset:2048
  v_sub_f32 v120, v120, v14
  v_sub_f32 v121, v121, v14
  v_cvt_pk_bf16_f32 v6, v120, v121
  v_lshlrev_b32 v120, 16, v6
  v_and_b32 v121, 0xffff0000, v6
  v_mul_f32 v120, v120, v15
  v_mul_f32 v121, v121, v15
  v_cvt_pk_bf16_f32 v44, v120, v121
  v_sub_f32 v122, v122, v14
  v_sub_f32 v123, v123, v14
  v_cvt_pk_bf16_f32 v6, v122, v123
  v_lshlrev_b32 v122, 16, v6
  v_and_b32 v123, 0xffff0000, v6
  v_mul_f32 v122, v122, v15
  v_mul_f32 v123, v123, v15
  v_cvt_pk_bf16_f32 v45, v122, v123
  v_sub_f32 v124, v124, v14
  v_sub_f32 v125, v125, v14
  v_cvt_pk_bf16_f32 v6, v124, v125
  v_lshlrev_b32 v124, 16, v6
  v_and_b32 v125, 0xffff0000, v6
  v_mul_f32 v124, v124, v15
  v_mul_f32 v125, v125, v15
  v_cvt_pk_bf16_f32 v46, v124, v125
  v_sub_f32 v126, v126, v14
  v_sub_f32 v127, v127, v14
  v_cvt_pk_bf16_f32 v6, v126, v127
  v_lshlrev_b32 v126, 16, v6
  v_and_b32 v127, 0xffff0000, v6
  v_mul_f32 v126, v126, v15
  v_mul_f32 v127, v127, v15
  v_cvt_pk_bf16_f32 v47, v126, v127
  buffer_store_dwordx4 v[44:47], v8, s[8:11], s34 offen offset:3072
  s_endpgm
K0_WQ:
  s_mov_b32 s12, s18
  s_and_b32 s13, s19, 0xffff
  s_mov_b32 s14, 1572864
  s_mov_b32 s15, 0x00020000
  s_sub_u32 s33, s2, 256
  s_lshl_b32 s33, s33, 2
  s_add_u32 s33, s33, s3
  s_mov_b32 s32, 0xaaaaaab
  s_mul_hi_u32 s34, s33, s32
  s_mul_i32 s35, s34, 24
  s_sub_u32 s35, s33, s35
  v_lshrrev_b32 v3, 3, v2
  v_and_b32 v4, 7, v2
  s_mov_b32 s38, 24576
  v_mul_lo_u32 v5, v3, s38
  v_lshl_add_u32 v5, v4, 4, v5
  s_mul_i32 s36, s34, 196608
  s_lshl_b32 s37, s35, 7
  s_add_u32 s36, s36, s37
  buffer_load_dwordx4 v[16:19], v5, s[12:15], s36 offen
  s_add_u32 s36, s36, 3072
  buffer_load_dwordx4 v[20:23], v5, s[12:15], s36 offen
  s_add_u32 s36, s36, 3072
  buffer_load_dwordx4 v[24:27], v5, s[12:15], s36 offen
  s_add_u32 s36, s36, 3072
  buffer_load_dwordx4 v[28:31], v5, s[12:15], s36 offen
  s_add_u32 s36, s36, 3072
  buffer_load_dwordx4 v[32:35], v5, s[12:15], s36 offen
  s_add_u32 s36, s36, 3072
  buffer_load_dwordx4 v[36:39], v5, s[12:15], s36 offen
  s_add_u32 s36, s36, 3072
  buffer_load_dwordx4 v[40:43], v5, s[12:15], s36 offen
  s_add_u32 s36, s36, 3072
  buffer_load_dwordx4 v[44:47], v5, s[12:15], s36 offen
  s_and_b32 s36, s35, 7
  s_mul_i32 s36, s36, 196608
  s_lshr_b32 s37, s35, 3
  s_lshl_b32 s37, s37, 10
  s_add_u32 s36, s36, s37
  s_lshr_b32 s37, s34, 1
  s_mul_i32 s37, s37, 24576
  s_add_u32 s36, s36, s37
  s_and_b32 s37, s34, 1
  s_lshl_b32 s37, s37, 9
  s_add_u32 s36, s36, s37
  s_add_u32 s36, s36, 3145728
  v_lshrrev_b32 v6, 2, v4
  v_lshl_add_u32 v6, v6, 3, v3
  v_lshlrev_b32 v6, 9, v6
  v_and_b32 v7, 3, v4
  v_lshl_add_u32 v6, v7, 7, v6
  s_lshl_b32 s42, s3, 13
  v_add_u32 v6, s42, v6
  v_lshlrev_b32 v7, 4, v2
  v_add_u32 v7, s42, v7
  v_lshrrev_b32 v9, 5, v2
  v_mul_u32_u24 v9, 3072, v9
  v_and_b32 v10, 31, v2
  v_lshl_add_u32 v9, v10, 4, v9
  s_waitcnt vmcnt(0)
  v_perm_b32 v64, v20, v16, s40
  v_perm_b32 v65, v28, v24, s40
  v_perm_b32 v66, v36, v32, s40
  v_perm_b32 v67, v44, v40, s40
  v_perm_b32 v68, v20, v16, s41
  v_perm_b32 v69, v28, v24, s41
  v_perm_b32 v70, v36, v32, s41
  v_perm_b32 v71, v44, v40, s41
  v_perm_b32 v72, v21, v17, s40
  v_perm_b32 v73, v29, v25, s40
  v_perm_b32 v74, v37, v33, s40
  v_perm_b32 v75, v45, v41, s40
  v_perm_b32 v76, v21, v17, s41
  v_perm_b32 v77, v29, v25, s41
  v_perm_b32 v78, v37, v33, s41
  v_perm_b32 v79, v45, v41, s41
  v_perm_b32 v80, v22, v18, s40
  v_perm_b32 v81, v30, v26, s40
  v_perm_b32 v82, v38, v34, s40
  v_perm_b32 v83, v46, v42, s40
  v_perm_b32 v84, v22, v18, s41
  v_perm_b32 v85, v30, v26, s41
  v_perm_b32 v86, v38, v34, s41
  v_perm_b32 v87, v46, v42, s41
  v_perm_b32 v88, v23, v19, s40
  v_perm_b32 v89, v31, v27, s40
  v_perm_b32 v90, v39, v35, s40
  v_perm_b32 v91, v47, v43, s40
  v_perm_b32 v92, v23, v19, s41
  v_perm_b32 v93, v31, v27, s41
  v_perm_b32 v94, v39, v35, s41
  v_perm_b32 v95, v47, v43, s41
  ds_write_b128 v6, v[64:67] offset:0
  ds_write_b128 v6, v[68:71] offset:16
  ds_write_b128 v6, v[72:75] offset:32
  ds_write_b128 v6, v[76:79] offset:48
  ds_write_b128 v6, v[80:83] offset:64
  ds_write_b128 v6, v[84:87] offset:80
  ds_write_b128 v6, v[88:91] offset:96
  ds_write_b128 v6, v[92:95] offset:112
  s_waitcnt lgkmcnt(0)
  ds_read_b128 v[64:67], v7 offset:0
  ds_read_b128 v[68:71], v7 offset:1024
  ds_read_b128 v[72:75], v7 offset:2048
  ds_read_b128 v[76:79], v7 offset:3072
  ds_read_b128 v[80:83], v7 offset:4096
  ds_read_b128 v[84:87], v7 offset:5120
  ds_read_b128 v[88:91], v7 offset:6144
  ds_read_b128 v[92:95], v7 offset:7168
  s_waitcnt lgkmcnt(0)
  buffer_store_dwordx4 v[64:67], v9, s[8:11], s36 offen
  s_add_u32 s36, s36, 6144
  buffer_store_dwordx4 v[68:71], v9, s[8:11], s36 offen
  s_add_u32 s36, s36, 6144
  buffer_store_dwordx4 v[72:75], v9, s[8:11], s36 offen
  s_add_u32 s36, s36, 6144
  buffer_store_dwordx4 v[76:79], v9, s[8:11], s36 offen
  s_add_u32 s36, s36, 79872
  buffer_store_dwordx4 v[80:83], v9, s[8:11], s36 offen
  s_add_u32 s36, s36, 6144
  buffer_store_dwordx4 v[84:87], v9, s[8:11], s36 offen
  s_add_u32 s36, s36, 6144
  buffer_store_dwordx4 v[88:91], v9, s[8:11], s36 offen
  s_add_u32 s36, s36, 6144
  buffer_store_dwordx4 v[92:95], v9, s[8:11], s36 offen
  s_add_u32 s36, s36, 6144
  s_endpgm
K0_WO:
  s_mov_b32 s12, s20
  s_and_b32 s13, s21, 0xffff
  s_mov_b32 s14, 524288
  s_mov_b32 s15, 0x00020000
  s_sub_u32 s33, s2, 304
  s_lshl_b32 s33, s33, 2
  s_add_u32 s33, s33, s3
  v_lshlrev_b32 v8, 4, v2
  s_and_b32 s35, s33, 7
  s_lshr_b32 s34, s33, 3
  v_lshrrev_b32 v3, 4, v2
  v_bfe_u32 v12, v2, 3, 1
  v_and_b32 v4, 7, v2
  v_lshlrev_b32 v5, 14, v3
  v_lshl_add_u32 v5, v12, 12, v5
  v_lshl_add_u32 v5, v4, 4, v5
  v_add_u32 v9, 8192, v5
  s_lshl_b32 s36, s34, 16
  s_lshl_b32 s37, s35, 7
  s_add_u32 s36, s36, s37
  buffer_load_dwordx4 v[16:19], v5, s[12:15], s36 offen offset:0
  buffer_load_dwordx4 v[20:23], v5, s[12:15], s36 offen offset:1024
  buffer_load_dwordx4 v[24:27], v5, s[12:15], s36 offen offset:2048
  buffer_load_dwordx4 v[28:31], v5, s[12:15], s36 offen offset:3072
  buffer_load_dwordx4 v[32:35], v9, s[12:15], s36 offen offset:0
  buffer_load_dwordx4 v[36:39], v9, s[12:15], s36 offen offset:1024
  buffer_load_dwordx4 v[40:43], v9, s[12:15], s36 offen offset:2048
  buffer_load_dwordx4 v[44:47], v9, s[12:15], s36 offen offset:3072
  v_lshrrev_b32 v6, 2, v4
  v_lshl_add_u32 v6, v6, 2, v3
  v_lshlrev_b32 v6, 10, v6
  v_lshl_add_u32 v6, v12, 9, v6
  v_and_b32 v7, 3, v4
  v_lshl_add_u32 v6, v7, 7, v6
  s_lshl_b32 s42, s3, 13
  v_add_u32 v6, s42, v6
  v_add_u32 v7, s42, v8
  s_mul_i32 s36, s35, 65536
  s_lshl_b32 s37, s34, 12
  s_add_u32 s36, s36, s37
  s_add_u32 s36, s36, 7340032
  s_add_u32 s37, s36, 32768
  s_cmp_eq_u32 s34, 999
  s_cselect_b32 s42, 0x7ff00000, 0
  v_add_u32 v9, s42, v8
  s_waitcnt vmcnt(0)
  v_perm_b32 v64, v20, v16, s40
  v_perm_b32 v65, v28, v24, s40
  v_perm_b32 v66, v36, v32, s40
  v_perm_b32 v67, v44, v40, s40
  v_perm_b32 v68, v20, v16, s41
  v_perm_b32 v69, v28, v24, s41
  v_perm_b32 v70, v36, v32, s41
  v_perm_b32 v71, v44, v40, s41
  v_perm_b32 v72, v21, v17, s40
  v_perm_b32 v73, v29, v25, s40
  v_perm_b32 v74, v37, v33, s40
  v_perm_b32 v75, v45, v41, s40
  v_perm_b32 v76, v21, v17, s41
  v_perm_b32 v77, v29, v25, s41
  v_perm_b32 v78, v37, v33, s41
  v_perm_b32 v79, v45, v41, s41
  v_perm_b32 v80, v22, v18, s40
  v_perm_b32 v81, v30, v26, s40
  v_perm_b32 v82, v38, v34, s40
  v_perm_b32 v83, v46, v42, s40
  v_perm_b32 v84, v22, v18, s41
  v_perm_b32 v85, v30, v26, s41
  v_perm_b32 v86, v38, v34, s41
  v_perm_b32 v87, v46, v42, s41
  v_perm_b32 v88, v23, v19, s40
  v_perm_b32 v89, v31, v27, s40
  v_perm_b32 v90, v39, v35, s40
  v_perm_b32 v91, v47, v43, s40
  v_perm_b32 v92, v23, v19, s41
  v_perm_b32 v93, v31, v27, s41
  v_perm_b32 v94, v39, v35, s41
  v_perm_b32 v95, v47, v43, s41
  ds_write_b128 v6, v[64:67] offset:0
  ds_write_b128 v6, v[68:71] offset:16
  ds_write_b128 v6, v[72:75] offset:32
  ds_write_b128 v6, v[76:79] offset:48
  ds_write_b128 v6, v[80:83] offset:64
  ds_write_b128 v6, v[84:87] offset:80
  ds_write_b128 v6, v[88:91] offset:96
  ds_write_b128 v6, v[92:95] offset:112
  s_waitcnt lgkmcnt(0)
  ds_read_b128 v[64:67], v7 offset:0
  ds_read_b128 v[68:71], v7 offset:1024
  ds_read_b128 v[72:75], v7 offset:2048
  ds_read_b128 v[76:79], v7 offset:3072
  ds_read_b128 v[80:83], v7 offset:4096
  ds_read_b128 v[84:87], v7 offset:5120
  ds_read_b128 v[88:91], v7 offset:6144
  ds_read_b128 v[92:95], v7 offset:7168
  s_waitcnt lgkmcnt(0)
  buffer_store_dwordx4 v[64:67], v8, s[8:11], s36 offen offset:0
  buffer_store_dwordx4 v[68:71], v8, s[8:11], s36 offen offset:1024
  buffer_store_dwordx4 v[72:75], v9, s[8:11], s36 offen offset:2048
  buffer_store_dwordx4 v[76:79], v9, s[8:11], s36 offen offset:3072
  buffer_store_dwordx4 v[80:83], v8, s[8:11], s37 offen offset:0
  buffer_store_dwordx4 v[84:87], v8, s[8:11], s37 offen offset:1024
  buffer_store_dwordx4 v[88:91], v9, s[8:11], s37 offen offset:2048
  buffer_store_dwordx4 v[92:95], v9, s[8:11], s37 offen offset:3072
K0_END:
  s_endpgm
.globl km_kernel
.p2align 8
.type km_kernel,@function
km_kernel:
  s_cmp_ge_u32 s2, 256
  s_cbranch_scc1 KM_END
  s_load_dwordx2 s[4:5], s[0:1], 88
  s_load_dwordx2 s[6:7], s[0:1], 0
  s_load_dwordx2 s[20:21], s[0:1], 72
  s_load_dwordx4 s[24:27], s[0:1], 32
  s_load_dwordx2 s[28:29], s[0:1], 48
  v_lshrrev_b32 v1, 6, v0
  v_and_b32 v2, 63, v0
  v_readfirstlane_b32 s3, v1
  v_lshlrev_b32 v8, 4, v2
  s_bfe_u32 s33, s2, 0x20001
  s_lshl_b32 s33, s33, 2
  s_bfe_u32 s34, s2, 0x20003
  s_add_u32 s33, s33, s34
  s_and_b32 s34, s2, 1
  s_lshl_b32 s34, s34, 3
  s_lshr_b32 s35, s2, 5
  s_add_u32 s34, s34, s35
  s_and_b32 s50, s3, 3
  s_lshl_b32 s36, s33, 2
  s_add_u32 s36, s36, s50
  s_waitcnt lgkmcnt(0)
  s_mov_b32 s8, s4
  s_and_b32 s9, s5, 0xffff
  s_mov_b32 s10, 33554432
  s_mov_b32 s11, 0x00020000
  s_mov_b32 s12, s6
  s_and_b32 s13, s7, 0xffff
  s_mov_b32 s14, 2097152
  s_mov_b32 s15, 0x00020000
  s_mov_b32 s16, s20
  s_and_b32 s17, s21, 0xffff
  s_mov_b32 s18, 2097152
  s_mov_b32 s19, 0x00020000
  s_cmp_ge_u32 s3, 4
  s_cbranch_scc1 KM_LOADER
  v_lshlrev_b32 v3, 3, v0
  s_mov_b32 s35, 0
  buffer_load_dwordx2 v[16:17], v3, s[8:11], s35 offen
  buffer_load_dwordx2 v[24:25], v3, s[8:11], s35 offen offset:2048
  s_mov_b32 s35, 12288
  buffer_load_dwordx2 v[18:19], v3, s[8:11], s35 offen
  buffer_load_dwordx2 v[26:27], v3, s[8:11], s35 offen offset:2048
  s_mov_b32 s35, 24576
  buffer_load_dwordx2 v[20:21], v3, s[8:11], s35 offen
  buffer_load_dwordx2 v[28:29], v3, s[8:11], s35 offen offset:2048
  s_mov_b32 s35, 36864
  buffer_load_dwordx2 v[22:23], v3, s[8:11], s35 offen
  buffer_load_dwordx2 v[30:31], v3, s[8:11], s35 offen offset:2048
  s_lshl_b32 s37, s36, 15
  s_add_u32 s37, s37, 1048576
  buffer_load_dwordx4 v[112:115], v8, s[8:11], s37 offen offset:0
  buffer_load_dwordx4 v[116:119], v8, s[8:11], s37 offen offset:1024
  buffer_load_dwordx4 v[120:123], v8, s[8:11], s37 offen offset:2048
  buffer_load_dwordx4 v[124:127], v8, s[8:11], s37 offen offset:3072
  s_add_u32 s37, s37, 4096
  buffer_load_dwordx4 v[128:131], v8, s[8:11], s37 offen offset:0
  buffer_load_dwordx4 v[132:135], v8, s[8:11], s37 offen offset:1024
  buffer_load_dwordx4 v[136:139], v8, s[8:11], s37 offen offset:2048
  buffer_load_dwordx4 v[140:143], v8, s[8:11], s37 offen offset:3072
  s_add_u32 s37, s37, 4096
  v_lshrrev_b32 v4, 6, v0
  v_bfe_u32 v5, v0, 2, 3
  v_lshl_add_u32 v4, v4, 3, v5
  v_bfe_u32 v5, v0, 5, 1
  v_lshl_add_u32 v4, v4, 1, v5
  v_and_b32 v5, 3, v0
  v_lshlrev_b32 v4, 5, v4
  v_lshl_add_u32 v4, v5, 3, v4
  v_add_u32 v4, 98304, v4
  v_lshrrev_b32 v5, 5, v2
  v_lshlrev_b32 v10, 5, v5
  v_add_u32 v10, 98304, v10
  v_mov_b32 v9, v8
  s_mov_b32 s41, 0
  v_mov_b32 v144, 0
  v_mov_b32 v145, 0
  v_mov_b32 v146, 0
  v_mov_b32 v147, 0
  v_mov_b32 v148, 0
  v_mov_b32 v149, 0
  v_mov_b32 v150, 0
  v_mov_b32 v151, 0
  v_mov_b32 v152, 0
  v_mov_b32 v153, 0
  v_mov_b32 v154, 0
  v_mov_b32 v155, 0
  v_mov_b32 v156, 0
  v_mov_b32 v157, 0
  v_mov_b32 v158, 0
  v_mov_b32 v159, 0
  v_mov_b32 v160, 0
  v_mov_b32 v161, 0
  v_mov_b32 v162, 0
  v_mov_b32 v163, 0
  v_mov_b32 v164, 0
  v_mov_b32 v165, 0
  v_mov_b32 v166, 0
  v_mov_b32 v167, 0
  v_mov_b32 v168, 0
  v_mov_b32 v169, 0
  v_mov_b32 v170, 0
  v_mov_b32 v171, 0
  v_mov_b32 v172, 0
  v_mov_b32 v173, 0
  v_mov_b32 v174, 0
  v_mov_b32 v175, 0
  v_mov_b32 v176, 0
  v_mov_b32 v177, 0
  v_mov_b32 v178, 0
  v_mov_b32 v179, 0
  v_mov_b32 v180, 0
  v_mov_b32 v181, 0
  v_mov_b32 v182, 0
  v_mov_b32 v183, 0
  v_mov_b32 v184, 0
  v_mov_b32 v185, 0
  v_mov_b32 v186, 0
  v_mov_b32 v187, 0
  v_mov_b32 v188, 0
  v_mov_b32 v189, 0
  v_mov_b32 v190, 0
  v_mov_b32 v191, 0
  s_waitcnt vmcnt(8)
  v_add_f32 v16, v16, v18
  v_add_f32 v20, v20, v22
  v_add_f32 v16, v16, v20
  v_cvt_pk_bf16_f32 v16, v16, v16
  v_lshlrev_b32 v16, 16, v16
  v_add_f32 v17, v17, v19
  v_add_f32 v21, v21, v23
  v_add_f32 v17, v17, v21
  v_cvt_pk_bf16_f32 v17, v17, v17
  v_lshlrev_b32 v17, 16, v17
  v_add_f32 v24, v24, v26
  v_add_f32 v28, v28, v30
  v_add_f32 v24, v24, v28
  v_cvt_pk_bf16_f32 v24, v24, v24
  v_lshlrev_b32 v24, 16, v24
  v_add_f32 v25, v25, v27
  v_add_f32 v29, v29, v31
  v_add_f32 v25, v25, v29
  v_cvt_pk_bf16_f32 v25, v25, v25
  v_lshlrev_b32 v25, 16, v25
  v_add_f32 v24, 1.0, v24
  v_cvt_pk_bf16_f32 v24, v24, v24
  v_lshlrev_b32 v24, 16, v24
  v_add_f32 v25, 1.0, v25
  v_cvt_pk_bf16_f32 v25, v25, v25
  v_lshlrev_b32 v25, 16, v25
  ds_write_b64 v4, v[24:25]
  ds_write_b64 v4, v[16:17] offset:2048
  s_waitcnt lgkmcnt(0)
  s_barrier
  ds_read_b128 v[80:83], v10 offset:0
  ds_read_b128 v[84:87], v10 offset:16
  ds_read_b128 v[88:91], v10 offset:2048
  ds_read_b128 v[92:95], v10 offset:2064
  ds_read_b128 v[32:35], v9 offset:0
  ds_read_b128 v[36:39], v9 offset:1024
  ds_read_b128 v[40:43], v9 offset:2048
  ds_read_b128 v[96:99], v10 offset:64
  ds_read_b128 v[100:103], v10 offset:80
  ds_read_b128 v[104:107], v10 offset:2112
  ds_read_b128 v[108:111], v10 offset:2128
  ds_read_b128 v[44:47], v9 offset:3072
  ds_read_b128 v[48:51], v9 offset:4096
  ds_read_b128 v[52:55], v9 offset:5120
  s_waitcnt vmcnt(7) lgkmcnt(10)
  v_lshlrev_b32 v16, 16, v112
  v_and_b32 v17, 0xffff0000, v112
  v_lshlrev_b32 v18, 16, v113
  v_and_b32 v19, 0xffff0000, v113
  v_lshlrev_b32 v20, 16, v114
  v_and_b32 v21, 0xffff0000, v114
  v_lshlrev_b32 v22, 16, v115
  v_and_b32 v23, 0xffff0000, v115
  v_fma_f32 v16, v16, v80, v88
  v_fma_f32 v17, v17, v81, v89
  v_fma_f32 v18, v18, v82, v90
  v_fma_f32 v19, v19, v83, v91
  v_fma_f32 v20, v20, v84, v92
  v_fma_f32 v21, v21, v85, v93
  v_fma_f32 v22, v22, v86, v94
  v_fma_f32 v23, v23, v87, v95
  v_cvt_pk_bf16_f32 v112, v16, v17
  v_cvt_pk_bf16_f32 v113, v18, v19
  v_cvt_pk_bf16_f32 v114, v20, v21
  v_cvt_pk_bf16_f32 v115, v22, v23
  s_and_b32 s35, s3, 1
  s_cmp_lg_u32 s35, 0
  s_cbranch_scc1 P1_LOOPB
P1_LOOPA:
  ds_read_b128 v[80:83], v10 offset:128
  ds_read_b128 v[84:87], v10 offset:144
  ds_read_b128 v[88:91], v10 offset:2176
  ds_read_b128 v[92:95], v10 offset:2192
  ds_read_b128 v[56:59], v9 offset:6144
  ds_read_b128 v[60:63], v9 offset:7168
  ds_read_b128 v[64:67], v9 offset:8192
  s_waitcnt vmcnt(6) lgkmcnt(10)
  v_mfma_f32_32x32x16_bf16 v[144:159], v[32:35], v[112:115], v[144:159]
  v_lshlrev_b32 v16, 16, v116
  v_and_b32 v17, 0xffff0000, v116
  v_lshlrev_b32 v18, 16, v117
  v_and_b32 v19, 0xffff0000, v117
  v_lshlrev_b32 v20, 16, v118
  v_and_b32 v21, 0xffff0000, v118
  v_lshlrev_b32 v22, 16, v119
  v_mfma_f32_32x32x16_bf16 v[160:175], v[36:39], v[112:115], v[160:175]
  v_and_b32 v23, 0xffff0000, v119
  v_fma_f32 v16, v16, v96, v104
  v_fma_f32 v17, v17, v97, v105
  v_fma_f32 v18, v18, v98, v106
  v_fma_f32 v19, v19, v99, v107
  v_fma_f32 v20, v20, v100, v108
  v_fma_f32 v21, v21, v101, v109
  v_mfma_f32_32x32x16_bf16 v[176:191], v[40:43], v[112:115], v[176:191]
  v_fma_f32 v22, v22, v102, v110
  v_fma_f32 v23, v23, v103, v111
  v_cvt_pk_bf16_f32 v116, v16, v17
  v_cvt_pk_bf16_f32 v117, v18, v19
  v_cvt_pk_bf16_f32 v118, v20, v21
  v_cvt_pk_bf16_f32 v119, v22, v23
  buffer_load_dwordx4 v[112:115], v8, s[8:11], s37 offen offset:0
  ds_read_b128 v[96:99], v10 offset:192
  ds_read_b128 v[100:103], v10 offset:208
  ds_read_b128 v[104:107], v10 offset:2240
  ds_read_b128 v[108:111], v10 offset:2256
  ds_read_b128 v[68:71], v9 offset:9216
  ds_read_b128 v[72:75], v9 offset:10240
  ds_read_b128 v[76:79], v9 offset:11264
  s_waitcnt vmcnt(6) lgkmcnt(10)
  v_mfma_f32_32x32x16_bf16 v[144:159], v[44:47], v[116:119], v[144:159]
  v_lshlrev_b32 v16, 16, v120
  v_and_b32 v17, 0xffff0000, v120
  v_lshlrev_b32 v18, 16, v121
  v_and_b32 v19, 0xffff0000, v121
  v_lshlrev_b32 v20, 16, v122
  v_and_b32 v21, 0xffff0000, v122
  v_lshlrev_b32 v22, 16, v123
  v_mfma_f32_32x32x16_bf16 v[160:175], v[48:51], v[116:119], v[160:175]
  v_and_b32 v23, 0xffff0000, v123
  v_fma_f32 v16, v16, v80, v88
  v_fma_f32 v17, v17, v81, v89
  v_fma_f32 v18, v18, v82, v90
  v_fma_f32 v19, v19, v83, v91
  v_fma_f32 v20, v20, v84, v92
  v_fma_f32 v21, v21, v85, v93
  v_mfma_f32_32x32x16_bf16 v[176:191], v[52:55], v[116:119], v[176:191]
  v_fma_f32 v22, v22, v86, v94
  v_fma_f32 v23, v23, v87, v95
  v_cvt_pk_bf16_f32 v120, v16, v17
  v_cvt_pk_bf16_f32 v121, v18, v19
  v_cvt_pk_bf16_f32 v122, v20, v21
  v_cvt_pk_bf16_f32 v123, v22, v23
  buffer_load_dwordx4 v[116:119], v8, s[8:11], s37 offen offset:1024
  s_barrier
  ds_read_b128 v[80:83], v10 offset:256
  ds_read_b128 v[84:87], v10 offset:272
  ds_read_b128 v[88:91], v10 offset:2304
  ds_read_b128 v[92:95], v10 offset:2320
  ds_read_b128 v[32:35], v9 offset:12288
  ds_read_b128 v[36:39], v9 offset:13312
  ds_read_b128 v[40:43], v9 offset:14336
  s_waitcnt vmcnt(6) lgkmcnt(10)
  v_mfma_f32_32x32x16_bf16 v[144:159], v[56:59], v[120:123], v[144:159]
  v_lshlrev_b32 v16, 16, v124
  v_and_b32 v17, 0xffff0000, v124
  v_lshlrev_b32 v18, 16, v125
  v_and_b32 v19, 0xffff0000, v125
  v_lshlrev_b32 v20, 16, v126
  v_and_b32 v21, 0xffff0000, v126
  v_lshlrev_b32 v22, 16, v127
  v_mfma_f32_32x32x16_bf16 v[160:175], v[60:63], v[120:123], v[160:175]
  v_and_b32 v23, 0xffff0000, v127
  v_fma_f32 v16, v16, v96, v104
  v_fma_f32 v17, v17, v97, v105
  v_fma_f32 v18, v18, v98, v106
  v_fma_f32 v19, v19, v99, v107
  v_fma_f32 v20, v20, v100, v108
  v_fma_f32 v21, v21, v101, v109
  v_mfma_f32_32x32x16_bf16 v[176:191], v[64:67], v[120:123], v[176:191]
  v_fma_f32 v22, v22, v102, v110
  v_fma_f32 v23, v23, v103, v111
  v_cvt_pk_bf16_f32 v124, v16, v17
  v_cvt_pk_bf16_f32 v125, v18, v19
  v_cvt_pk_bf16_f32 v126, v20, v21
  v_cvt_pk_bf16_f32 v127, v22, v23
  buffer_load_dwordx4 v[120:123], v8, s[8:11], s37 offen offset:2048
  ds_read_b128 v[96:99], v10 offset:320
  ds_read_b128 v[100:103], v10 offset:336
  ds_read_b128 v[104:107], v10 offset:2368
  ds_read_b128 v[108:111], v10 offset:2384
  ds_read_b128 v[44:47], v9 offset:15360
  ds_read_b128 v[48:51], v9 offset:16384
  ds_read_b128 v[52:55], v9 offset:17408
  s_waitcnt vmcnt(6) lgkmcnt(10)
  v_mfma_f32_32x32x16_bf16 v[144:159], v[68:71], v[124:127], v[144:159]
  v_lshlrev_b32 v16, 16, v128
  v_and_b32 v17, 0xffff0000, v128
  v_lshlrev_b32 v18, 16, v129
  v_and_b32 v19, 0xffff0000, v129
  v_lshlrev_b32 v20, 16, v130
  v_and_b32 v21, 0xffff0000, v130
  v_lshlrev_b32 v22, 16, v131
  v_mfma_f32_32x32x16_bf16 v[160:175], v[72:75], v[124:127], v[160:175]
  v_and_b32 v23, 0xffff0000, v131
  v_fma_f32 v16, v16, v80, v88
  v_fma_f32 v17, v17, v81, v89
  v_fma_f32 v18, v18, v82, v90
  v_fma_f32 v19, v19, v83, v91
  v_fma_f32 v20, v20, v84, v92
  v_fma_f32 v21, v21, v85, v93
  v_mfma_f32_32x32x16_bf16 v[176:191], v[76:79], v[124:127], v[176:191]
  v_fma_f32 v22, v22, v86, v94
  v_fma_f32 v23, v23, v87, v95
  v_cvt_pk_bf16_f32 v128, v16, v17
  v_cvt_pk_bf16_f32 v129, v18, v19
  v_cvt_pk_bf16_f32 v130, v20, v21
  v_cvt_pk_bf16_f32 v131, v22, v23
  buffer_load_dwordx4 v[124:127], v8, s[8:11], s37 offen offset:3072
  s_add_u32 s37, s37, 4096
  ds_read_b128 v[80:83], v10 offset:384
  ds_read_b128 v[84:87], v10 offset:400
  ds_read_b128 v[88:91], v10 offset:2432
  ds_read_b128 v[92:95], v10 offset:2448
  ds_read_b128 v[56:59], v9 offset:18432
  ds_read_b128 v[60:63], v9 offset:19456
  ds_read_b128 v[64:67], v9 offset:20480
  s_waitcnt vmcnt(6) lgkmcnt(10)
  v_mfma_f32_32x32x16_bf16 v[144:159], v[32:35], v[128:131], v[144:159]
  v_lshlrev_b32 v16, 16, v132
  v_and_b32 v17, 0xffff0000, v132
  v_lshlrev_b32 v18, 16, v133
  v_and_b32 v19, 0xffff0000, v133
  v_lshlrev_b32 v20, 16, v134
  v_and_b32 v21, 0xffff0000, v134
  v_lshlrev_b32 v22, 16, v135
  v_mfma_f32_32x32x16_bf16 v[160:175], v[36:39], v[128:131], v[160:175]
  v_and_b32 v23, 0xffff0000, v135
  v_fma_f32 v16, v16, v96, v104
  v_fma_f32 v17, v17, v97, v105
  v_fma_f32 v18, v18, v98, v106
  v_fma_f32 v19, v19, v99, v107
  v_fma_f32 v20, v20, v100, v108
  v_fma_f32 v21, v21, v101, v109
  v_mfma_f32_32x32x16_bf16 v[176:191], v[40:43], v[128:131], v[176:191]
  v_fma_f32 v22, v22, v102, v110
  v_fma_f32 v23, v23, v103, v111
  v_cvt_pk_bf16_f32 v132, v16, v17
  v_cvt_pk_bf16_f32 v133, v18, v19
  v_cvt_pk_bf16_f32 v134, v20, v21
  v_cvt_pk_bf16_f32 v135, v22, v23
  buffer_load_dwordx4 v[128:131], v8, s[8:11], s37 offen offset:0
  ds_read_b128 v[96:99], v10 offset:448
  ds_read_b128 v[100:103], v10 offset:464
  ds_read_b128 v[104:107], v10 offset:2496
  ds_read_b128 v[108:111], v10 offset:2512
  ds_read_b128 v[68:71], v9 offset:21504
  ds_read_b128 v[72:75], v9 offset:22528
  ds_read_b128 v[76:79], v9 offset:23552
  s_waitcnt vmcnt(6) lgkmcnt(10)
  v_mfma_f32_32x32x16_bf16 v[144:159], v[44:47], v[132:135], v[144:159]
  v_lshlrev_b32 v16, 16, v136
  v_and_b32 v17, 0xffff0000, v136
  v_lshlrev_b32 v18, 16, v137
  v_and_b32 v19, 0xffff0000, v137
  v_lshlrev_b32 v20, 16, v138
  v_and_b32 v21, 0xffff0000, v138
  v_lshlrev_b32 v22, 16, v139
  v_mfma_f32_32x32x16_bf16 v[160:175], v[48:51], v[132:135], v[160:175]
  v_and_b32 v23, 0xffff0000, v139
  v_fma_f32 v16, v16, v80, v88
  v_fma_f32 v17, v17, v81, v89
  v_fma_f32 v18, v18, v82, v90
  v_fma_f32 v19, v19, v83, v91
  v_fma_f32 v20, v20, v84, v92
  v_fma_f32 v21, v21, v85, v93
  v_mfma_f32_32x32x16_bf16 v[176:191], v[52:55], v[132:135], v[176:191]
  v_fma_f32 v22, v22, v86, v94
  v_fma_f32 v23, v23, v87, v95
  v_cvt_pk_bf16_f32 v136, v16, v17
  v_cvt_pk_bf16_f32 v137, v18, v19
  v_cvt_pk_bf16_f32 v138, v20, v21
  v_cvt_pk_bf16_f32 v139, v22, v23
  buffer_load_dwordx4 v[132:135], v8, s[8:11], s37 offen offset:1024
  s_barrier
  ds_read_b128 v[80:83], v10 offset:512
  ds_read_b128 v[84:87], v10 offset:528
  ds_read_b128 v[88:91], v10 offset:2560
  ds_read_b128 v[92:95], v10 offset:2576
  ds_read_b128 v[32:35], v9 offset:24576
  ds_read_b128 v[36:39], v9 offset:25600
  ds_read_b128 v[40:43], v9 offset:26624
  s_waitcnt vmcnt(6) lgkmcnt(10)
  v_mfma_f32_32x32x16_bf16 v[144:159], v[56:59], v[136:139], v[144:159]
  v_lshlrev_b32 v16, 16, v140
  v_and_b32 v17, 0xffff0000, v140
  v_lshlrev_b32 v18, 16, v141
  v_and_b32 v19, 0xffff0000, v141
  v_lshlrev_b32 v20, 16, v142
  v_and_b32 v21, 0xffff0000, v142
  v_lshlrev_b32 v22, 16, v143
  v_mfma_f32_32x32x16_bf16 v[160:175], v[60:63], v[136:139], v[160:175]
  v_and_b32 v23, 0xffff0000, v143
  v_fma_f32 v16, v16, v96, v104
  v_fma_f32 v17, v17, v97, v105
  v_fma_f32 v18, v18, v98, v106
  v_fma_f32 v19, v19, v99, v107
  v_fma_f32 v20, v20, v100, v108
  v_fma_f32 v21, v21, v101, v109
  v_mfma_f32_32x32x16_bf16 v[176:191], v[64:67], v[136:139], v[176:191]
  v_fma_f32 v22, v22, v102, v110
  v_fma_f32 v23, v23, v103, v111
  v_cvt_pk_bf16_f32 v140, v16, v17
  v_cvt_pk_bf16_f32 v141, v18, v19
  v_cvt_pk_bf16_f32 v142, v20, v21
  v_cvt_pk_bf16_f32 v143, v22, v23
  buffer_load_dwordx4 v[136:139], v8, s[8:11], s37 offen offset:2048
  ds_read_b128 v[96:99], v10 offset:576
  ds_read_b128 v[100:103], v10 offset:592
  ds_read_b128 v[104:107], v10 offset:2624
  ds_read_b128 v[108:111], v10 offset:2640
  ds_read_b128 v[44:47], v9 offset:27648
  ds_read_b128 v[48:51], v9 offset:28672
  ds_read_b128 v[52:55], v9 offset:29696
  s_waitcnt vmcnt(6) lgkmcnt(10)
  v_mfma_f32_32x32x16_bf16 v[144:159], v[68:71], v[140:143], v[144:159]
  v_lshlrev_b32 v16, 16, v112
  v_and_b32 v17, 0xffff0000, v112
  v_lshlrev_b32 v18, 16, v113
  v_and_b32 v19, 0xffff0000, v113
  v_lshlrev_b32 v20, 16, v114
  v_and_b32 v21, 0xffff0000, v114
  v_lshlrev_b32 v22, 16, v115
  v_mfma_f32_32x32x16_bf16 v[160:175], v[72:75], v[140:143], v[160:175]
  v_and_b32 v23, 0xffff0000, v115
  v_fma_f32 v16, v16, v80, v88
  v_fma_f32 v17, v17, v81, v89
  v_fma_f32 v18, v18, v82, v90
  v_fma_f32 v19, v19, v83, v91
  v_fma_f32 v20, v20, v84, v92
  v_fma_f32 v21, v21, v85, v93
  v_mfma_f32_32x32x16_bf16 v[176:191], v[76:79], v[140:143], v[176:191]
  v_fma_f32 v22, v22, v86, v94
  v_fma_f32 v23, v23, v87, v95
  v_cvt_pk_bf16_f32 v112, v16, v17
  v_cvt_pk_bf16_f32 v113, v18, v19
  v_cvt_pk_bf16_f32 v114, v20, v21
  v_cvt_pk_bf16_f32 v115, v22, v23
  buffer_load_dwordx4 v[140:143], v8, s[8:11], s37 offen offset:3072
  s_add_u32 s37, s37, 4096
  v_add_u32 v9, 24576, v9
  v_add_u32 v10, 512, v10
  s_add_u32 s41, s41, 1
  s_cmp_eq_u32 s41, 3
  s_cselect_b32 s37, 0x7ff00000, s37
  s_cmp_lt_u32 s41, 4
  s_cbranch_scc1 P1_LOOPA
  s_branch P1_LOOPE
P1_LOOPB:
  s_waitcnt vmcnt(6) lgkmcnt(3)
  v_mfma_f32_32x32x16_bf16 v[144:159], v[32:35], v[112:115], v[144:159]
  v_lshlrev_b32 v16, 16, v116
  v_and_b32 v17, 0xffff0000, v116
  v_lshlrev_b32 v18, 16, v117
  v_and_b32 v19, 0xffff0000, v117
  v_lshlrev_b32 v20, 16, v118
  v_and_b32 v21, 0xffff0000, v118
  v_lshlrev_b32 v22, 16, v119
  v_mfma_f32_32x32x16_bf16 v[160:175], v[36:39], v[112:115], v[160:175]
  v_and_b32 v23, 0xffff0000, v119
  v_fma_f32 v16, v16, v96, v104
  v_fma_f32 v17, v17, v97, v105
  v_fma_f32 v18, v18, v98, v106
  v_fma_f32 v19, v19, v99, v107
  v_fma_f32 v20, v20, v100, v108
  v_fma_f32 v21, v21, v101, v109
  ds_read_b128 v[80:83], v10 offset:128
  ds_read_b128 v[84:87], v10 offset:144
  ds_read_b128 v[88:91], v10 offset:2176
  ds_read_b128 v[92:95], v10 offset:2192
  ds_read_b128 v[56:59], v9 offset:6144
  ds_read_b128 v[60:63], v9 offset:7168
  ds_read_b128 v[64:67], v9 offset:8192
  v_mfma_f32_32x32x16_bf16 v[176:191], v[40:43], v[112:115], v[176:191]
  v_fma_f32 v22, v22, v102, v110
  v_fma_f32 v23, v23, v103, v111
  v_cvt_pk_bf16_f32 v116, v16, v17
  v_cvt_pk_bf16_f32 v117, v18, v19
  v_cvt_pk_bf16_f32 v118, v20, v21
  v_cvt_pk_bf16_f32 v119, v22, v23
  buffer_load_dwordx4 v[112:115], v8, s[8:11], s37 offen offset:0
  s_waitcnt vmcnt(6) lgkmcnt(3)
  v_mfma_f32_32x32x16_bf16 v[144:159], v[44:47], v[116:119], v[144:159]
  v_lshlrev_b32 v16, 16, v120
  v_and_b32 v17, 0xffff0000, v120
  v_lshlrev_b32 v18, 16, v121
  v_and_b32 v19, 0xffff0000, v121
  v_lshlrev_b32 v20, 16, v122
  v_and_b32 v21, 0xffff0000, v122
  v_lshlrev_b32 v22, 16, v123
  v_mfma_f32_32x32x16_bf16 v[160:175], v[48:51], v[116:119], v[160:175]
  v_and_b32 v23, 0xffff0000, v123
  v_fma_f32 v16, v16, v80, v88
  v_fma_f32 v17, v17, v81, v89
  v_fma_f32 v18, v18, v82, v90
  v_fma_f32 v19, v19, v83, v91
  v_fma_f32 v20, v20, v84, v92
  v_fma_f32 v21, v21, v85, v93
  ds_read_b128 v[96:99], v10 offset:192
  ds_read_b128 v[100:103], v10 offset:208
  ds_read_b128 v[104:107], v10 offset:2240
  ds_read_b128 v[108:111], v10 offset:2256
  ds_read_b128 v[68:71], v9 offset:9216
  ds_read_b128 v[72:75], v9 offset:10240
  ds_read_b128 v[76:79], v9 offset:11264
  v_mfma_f32_32x32x16_bf16 v[176:191], v[52:55], v[116:119], v[176:191]
  v_fma_f32 v22, v22, v86, v94
  v_fma_f32 v23, v23, v87, v95
  v_cvt_pk_bf16_f32 v120, v16, v17
  v_cvt_pk_bf16_f32 v121, v18, v19
  v_cvt_pk_bf16_f32 v122, v20, v21
  v_cvt_pk_bf16_f32 v123, v22, v23
  buffer_load_dwordx4 v[116:119], v8, s[8:11], s37 offen offset:1024
  s_barrier
  s_waitcnt vmcnt(6) lgkmcnt(3)
  v_mfma_f32_32x32x16_bf16 v[144:159], v[56:59], v[120:123], v[144:159]
  v_lshlrev_b32 v16, 16, v124
  v_and_b32 v17, 0xffff0000, v124
  v_lshlrev_b32 v18, 16, v125
  v_and_b32 v19, 0xffff0000, v125
  v_lshlrev_b32 v20, 16, v126
  v_and_b32 v21, 0xffff0000, v126
  v_lshlrev_b32 v22, 16, v127
  v_mfma_f32_32x32x16_bf16 v[160:175], v[60:63], v[120:123], v[160:175]
  v_and_b32 v23, 0xffff0000, v127
  v_fma_f32 v16, v16, v96, v104
  v_fma_f32 v17, v17, v97, v105
  v_fma_f32 v18, v18, v98, v106
  v_fma_f32 v19, v19, v99, v107
  v_fma_f32 v20, v20, v100, v108
  v_fma_f32 v21, v21, v101, v109
  ds_read_b128 v[80:83], v10 offset:256
  ds_read_b128 v[84:87], v10 offset:272
  ds_read_b128 v[88:91], v10 offset:2304
  ds_read_b128 v[92:95], v10 offset:2320
  ds_read_b128 v[32:35], v9 offset:12288
  ds_read_b128 v[36:39], v9 offset:13312
  ds_read_b128 v[40:43], v9 offset:14336
  v_mfma_f32_32x32x16_bf16 v[176:191], v[64:67], v[120:123], v[176:191]
  v_fma_f32 v22, v22, v102, v110
  v_fma_f32 v23, v23, v103, v111
  v_cvt_pk_bf16_f32 v124, v16, v17
  v_cvt_pk_bf16_f32 v125, v18, v19
  v_cvt_pk_bf16_f32 v126, v20, v21
  v_cvt_pk_bf16_f32 v127, v22, v23
  buffer_load_dwordx4 v[120:123], v8, s[8:11], s37 offen offset:2048
  s_waitcnt vmcnt(6) lgkmcnt(3)
  v_mfma_f32_32x32x16_bf16 v[144:159], v[68:71], v[124:127], v[144:159]
  v_lshlrev_b32 v16, 16, v128
  v_and_b32 v17, 0xffff0000, v128
  v_lshlrev_b32 v18, 16, v129
  v_and_b32 v19, 0xffff0000, v129
  v_lshlrev_b32 v20, 16, v130
  v_and_b32 v21, 0xffff0000, v130
  v_lshlrev_b32 v22, 16, v131
  v_mfma_f32_32x32x16_bf16 v[160:175], v[72:75], v[124:127], v[160:175]
  v_and_b32 v23, 0xffff0000, v131
  v_fma_f32 v16, v16, v80, v88
  v_fma_f32 v17, v17, v81, v89
  v_fma_f32 v18, v18, v82, v90
  v_fma_f32 v19, v19, v83, v91
  v_fma_f32 v20, v20, v84, v92
  v_fma_f32 v21, v21, v85, v93
  ds_read_b128 v[96:99], v10 offset:320
  ds_read_b128 v[100:103], v10 offset:336
  ds_read_b128 v[104:107], v10 offset:2368
  ds_read_b128 v[108:111], v10 offset:2384
  ds_read_b128 v[44:47], v9 offset:15360
  ds_read_b128 v[48:51], v9 offset:16384
  ds_read_b128 v[52:55], v9 offset:17408
  v_mfma_f32_32x32x16_bf16 v[176:191], v[76:79], v[124:127], v[176:191]
  v_fma_f32 v22, v22, v86, v94
  v_fma_f32 v23, v23, v87, v95
  v_cvt_pk_bf16_f32 v128, v16, v17
  v_cvt_pk_bf16_f32 v129, v18, v19
  v_cvt_pk_bf16_f32 v130, v20, v21
  v_cvt_pk_bf16_f32 v131, v22, v23
  buffer_load_dwordx4 v[124:127], v8, s[8:11], s37 offen offset:3072
  s_add_u32 s37, s37, 4096
  s_waitcnt vmcnt(6) lgkmcnt(3)
  v_mfma_f32_32x32x16_bf16 v[144:159], v[32:35], v[128:131], v[144:159]
  v_lshlrev_b32 v16, 16, v132
  v_and_b32 v17, 0xffff0000, v132
  v_lshlrev_b32 v18, 16, v133
  v_and_b32 v19, 0xffff0000, v133
  v_lshlrev_b32 v20, 16, v134
  v_and_b32 v21, 0xffff0000, v134
  v_lshlrev_b32 v22, 16, v135
  v_mfma_f32_32x32x16_bf16 v[160:175], v[36:39], v[128:131], v[160:175]
  v_and_b32 v23, 0xffff0000, v135
  v_fma_f32 v16, v16, v96, v104
  v_fma_f32 v17, v17, v97, v105
  v_fma_f32 v18, v18, v98, v106
  v_fma_f32 v19, v19, v99, v107
  v_fma_f32 v20, v20, v100, v108
  v_fma_f32 v21, v21, v101, v109
  ds_read_b128 v[80:83], v10 offset:384
  ds_read_b128 v[84:87], v10 offset:400
  ds_read_b128 v[88:91], v10 offset:2432
  ds_read_b128 v[92:95], v10 offset:2448
  ds_read_b128 v[56:59], v9 offset:18432
  ds_read_b128 v[60:63], v9 offset:19456
  ds_read_b128 v[64:67], v9 offset:20480
  v_mfma_f32_32x32x16_bf16 v[176:191], v[40:43], v[128:131], v[176:191]
  v_fma_f32 v22, v22, v102, v110
  v_fma_f32 v23, v23, v103, v111
  v_cvt_pk_bf16_f32 v132, v16, v17
  v_cvt_pk_bf16_f32 v133, v18, v19
  v_cvt_pk_bf16_f32 v134, v20, v21
  v_cvt_pk_bf16_f32 v135, v22, v23
  buffer_load_dwordx4 v[128:131], v8, s[8:11], s37 offen offset:0
  s_waitcnt vmcnt(6) lgkmcnt(3)
  v_mfma_f32_32x32x16_bf16 v[144:159], v[44:47], v[132:135], v[144:159]
  v_lshlrev_b32 v16, 16, v136
  v_and_b32 v17, 0xffff0000, v136
  v_lshlrev_b32 v18, 16, v137
  v_and_b32 v19, 0xffff0000, v137
  v_lshlrev_b32 v20, 16, v138
  v_and_b32 v21, 0xffff0000, v138
  v_lshlrev_b32 v22, 16, v139
  v_mfma_f32_32x32x16_bf16 v[160:175], v[48:51], v[132:135], v[160:175]
  v_and_b32 v23, 0xffff0000, v139
  v_fma_f32 v16, v16, v80, v88
  v_fma_f32 v17, v17, v81, v89
  v_fma_f32 v18, v18, v82, v90
  v_fma_f32 v19, v19, v83, v91
  v_fma_f32 v20, v20, v84, v92
  v_fma_f32 v21, v21, v85, v93
  ds_read_b128 v[96:99], v10 offset:448
  ds_read_b128 v[100:103], v10 offset:464
  ds_read_b128 v[104:107], v10 offset:2496
  ds_read_b128 v[108:111], v10 offset:2512
  ds_read_b128 v[68:71], v9 offset:21504
  ds_read_b128 v[72:75], v9 offset:22528
  ds_read_b128 v[76:79], v9 offset:23552
  v_mfma_f32_32x32x16_bf16 v[176:191], v[52:55], v[132:135], v[176:191]
  v_fma_f32 v22, v22, v86, v94
  v_fma_f32 v23, v23, v87, v95
  v_cvt_pk_bf16_f32 v136, v16, v17
  v_cvt_pk_bf16_f32 v137, v18, v19
  v_cvt_pk_bf16_f32 v138, v20, v21
  v_cvt_pk_bf16_f32 v139, v22, v23
  buffer_load_dwordx4 v[132:135], v8, s[8:11], s37 offen offset:1024
  s_barrier
  s_waitcnt vmcnt(6) lgkmcnt(3)
  v_mfma_f32_32x32x16_bf16 v[144:159], v[56:59], v[136:139], v[144:159]
  v_lshlrev_b32 v16, 16, v140
  v_and_b32 v17, 0xffff0000, v140
  v_lshlrev_b32 v18, 16, v141
  v_and_b32 v19, 0xffff0000, v141
  v_lshlrev_b32 v20, 16, v142
  v_and_b32 v21, 0xffff0000, v142
  v_lshlrev_b32 v22, 16, v143
  v_mfma_f32_32x32x16_bf16 v[160:175], v[60:63], v[136:139], v[160:175]
  v_and_b32 v23, 0xffff0000, v143
  v_fma_f32 v16, v16, v96, v104
  v_fma_f32 v17, v17, v97, v105
  v_fma_f32 v18, v18, v98, v106
  v_fma_f32 v19, v19, v99, v107
  v_fma_f32 v20, v20, v100, v108
  v_fma_f32 v21, v21, v101, v109
  ds_read_b128 v[80:83], v10 offset:512
  ds_read_b128 v[84:87], v10 offset:528
  ds_read_b128 v[88:91], v10 offset:2560
  ds_read_b128 v[92:95], v10 offset:2576
  ds_read_b128 v[32:35], v9 offset:24576
  ds_read_b128 v[36:39], v9 offset:25600
  ds_read_b128 v[40:43], v9 offset:26624
  v_mfma_f32_32x32x16_bf16 v[176:191], v[64:67], v[136:139], v[176:191]
  v_fma_f32 v22, v22, v102, v110
  v_fma_f32 v23, v23, v103, v111
  v_cvt_pk_bf16_f32 v140, v16, v17
  v_cvt_pk_bf16_f32 v141, v18, v19
  v_cvt_pk_bf16_f32 v142, v20, v21
  v_cvt_pk_bf16_f32 v143, v22, v23
  buffer_load_dwordx4 v[136:139], v8, s[8:11], s37 offen offset:2048
  s_waitcnt vmcnt(6) lgkmcnt(3)
  v_mfma_f32_32x32x16_bf16 v[144:159], v[68:71], v[140:143], v[144:159]
  v_lshlrev_b32 v16, 16, v112
  v_and_b32 v17, 0xffff0000, v112
  v_lshlrev_b32 v18, 16, v113
  v_and_b32 v19, 0xffff0000, v113
  v_lshlrev_b32 v20, 16, v114
  v_and_b32 v21, 0xffff0000, v114
  v_lshlrev_b32 v22, 16, v115
  v_mfma_f32_32x32x16_bf16 v[160:175], v[72:75], v[140:143], v[160:175]
  v_and_b32 v23, 0xffff0000, v115
  v_fma_f32 v16, v16, v80, v88
  v_fma_f32 v17, v17, v81, v89
  v_fma_f32 v18, v18, v82, v90
  v_fma_f32 v19, v19, v83, v91
  v_fma_f32 v20, v20, v84, v92
  v_fma_f32 v21, v21, v85, v93
  ds_read_b128 v[96:99], v10 offset:576
  ds_read_b128 v[100:103], v10 offset:592
  ds_read_b128 v[104:107], v10 offset:2624
  ds_read_b128 v[108:111], v10 offset:2640
  ds_read_b128 v[44:47], v9 offset:27648
  ds_read_b128 v[48:51], v9 offset:28672
  ds_read_b128 v[52:55], v9 offset:29696
  v_mfma_f32_32x32x16_bf16 v[176:191], v[76:79], v[140:143], v[176:191]
  v_fma_f32 v22, v22, v86, v94
  v_fma_f32 v23, v23, v87, v95
  v_cvt_pk_bf16_f32 v112, v16, v17
  v_cvt_pk_bf16_f32 v113, v18, v19
  v_cvt_pk_bf16_f32 v114, v20, v21
  v_cvt_pk_bf16_f32 v115, v22, v23
  buffer_load_dwordx4 v[140:143], v8, s[8:11], s37 offen offset:3072
  s_add_u32 s37, s37, 4096
  v_add_u32 v9, 24576, v9
  v_add_u32 v10, 512, v10
  s_add_u32 s41, s41, 1
  s_cmp_eq_u32 s41, 3
  s_cselect_b32 s37, 0x7ff00000, s37
  s_cmp_lt_u32 s41, 4
  s_cbranch_scc1 P1_LOOPB
P1_LOOPE:
  s_waitcnt vmcnt(0) lgkmcnt(0)
  s_nop 7
  s_barrier
  v_and_b32 v3, 31, v2
  v_lshrrev_b32 v4, 5, v2
  s_lshl_b32 s35, s3, 5
  v_add_u32 v5, s35, v3
  v_add_u32 v5, 16, v5
  v_mul_u32_u24 v6, 2304, v4
  v_lshl_add_u32 v15, v5, 4, v6
  v_add_u32 v15, 131072, v15
  v_mul_u32_u24 v6, 4608, v4
  v_lshl_add_u32 v7, v5, 4, v6
  v_add_u32 v7, 140288, v7
  v_cvt_pk_bf16_f32 v24, v160, v161
  v_cvt_pk_bf16_f32 v25, v162, v163
  v_cvt_pk_bf16_f32 v26, v164, v165
  v_cvt_pk_bf16_f32 v27, v166, v167
  v_cvt_pk_bf16_f32 v28, v168, v169
  v_cvt_pk_bf16_f32 v29, v170, v171
  v_cvt_pk_bf16_f32 v30, v172, v173
  v_cvt_pk_bf16_f32 v31, v174, v175
  v_cvt_pk_bf16_f32 v9, v176, v177
  v_lshlrev_b32 v176, 16, v9
  v_and_b32 v177, 0xffff0000, v9
  v_cvt_pk_bf16_f32 v9, v178, v179
  v_lshlrev_b32 v178, 16, v9
  v_and_b32 v179, 0xffff0000, v9
  v_cvt_pk_bf16_f32 v9, v180, v181
  v_lshlrev_b32 v180, 16, v9
  v_and_b32 v181, 0xffff0000, v9
  v_cvt_pk_bf16_f32 v9, v182, v183
  v_lshlrev_b32 v182, 16, v9
  v_and_b32 v183, 0xffff0000, v9
  v_cvt_pk_bf16_f32 v9, v184, v185
  v_lshlrev_b32 v184, 16, v9
  v_and_b32 v185, 0xffff0000, v9
  v_cvt_pk_bf16_f32 v9, v186, v187
  v_lshlrev_b32 v186, 16, v9
  v_and_b32 v187, 0xffff0000, v9
  v_cvt_pk_bf16_f32 v9, v188, v189
  v_lshlrev_b32 v188, 16, v9
  v_and_b32 v189, 0xffff0000, v9
  v_cvt_pk_bf16_f32 v9, v190, v191
  v_lshlrev_b32 v190, 16, v9
  v_and_b32 v191, 0xffff0000, v9
  ds_write_b128 v15, v[24:27]
  ds_write_b128 v15, v[28:31] offset:4608
  ds_write_b128 v7, v[176:179]
  ds_write_b128 v7, v[180:183] offset:2304
  ds_write_b128 v7, v[184:187] offset:9216
  ds_write_b128 v7, v[188:191] offset:11520
  v_cvt_pk_bf16_f32 v116, v144, v145
  v_cvt_pk_bf16_f32 v117, v146, v147
  v_cvt_pk_bf16_f32 v118, v148, v149
  v_cvt_pk_bf16_f32 v119, v150, v151
  v_cvt_pk_bf16_f32 v120, v152, v153
  v_cvt_pk_bf16_f32 v121, v154, v155
  v_cvt_pk_bf16_f32 v122, v156, v157
  v_cvt_pk_bf16_f32 v123, v158, v159
  v_subrev_u32 v15, 224, v15
  v_subrev_u32 v7, 224, v7
  s_waitcnt lgkmcnt(0)
  s_barrier
  ds_read_b128 v[32:35], v15 offset:224
  ds_read_b128 v[36:39], v15 offset:192
  ds_read_b128 v[40:43], v15 offset:160
  ds_read_b128 v[44:47], v15 offset:128
  ds_read_b128 v[48:51], v15 offset:96
  ds_read_b128 v[52:55], v15 offset:64
  ds_read_b128 v[56:59], v15 offset:32
  ds_read_b128 v[60:63], v15 offset:0
  ds_read_b128 v[64:67], v15 offset:4832
  ds_read_b128 v[68:71], v15 offset:4800
  ds_read_b128 v[72:75], v15 offset:4768
  ds_read_b128 v[76:79], v15 offset:4736
  ds_read_b128 v[80:83], v15 offset:4704
  ds_read_b128 v[84:87], v15 offset:4672
  ds_read_b128 v[88:91], v15 offset:4640
  ds_read_b128 v[92:95], v15 offset:4608
  s_waitcnt lgkmcnt(12)
  v_dot2_f32_bf16 v96, v116, v32, 0
  v_dot2_f32_bf16 v96, v117, v33, v96
  v_dot2_f32_bf16 v96, v118, v34, v96
  v_dot2_f32_bf16 v96, v119, v35, v96
  ds_read_b128 v[128:131], v7 offset:224
  ds_read_b128 v[132:135], v7 offset:2528
  v_dot2_f32_bf16 v97, v116, v36, 0
  v_dot2_f32_bf16 v97, v117, v37, v97
  v_dot2_f32_bf16 v97, v118, v38, v97
  v_dot2_f32_bf16 v97, v119, v39, v97
  ds_read_b128 v[136:139], v7 offset:192
  ds_read_b128 v[140:143], v7 offset:2496
  v_dot2_f32_bf16 v98, v116, v40, 0
  v_dot2_f32_bf16 v98, v117, v41, v98
  v_dot2_f32_bf16 v98, v118, v42, v98
  v_dot2_f32_bf16 v98, v119, v43, v98
  ds_read_b128 v[144:147], v7 offset:160
  ds_read_b128 v[148:151], v7 offset:2464
  v_dot2_f32_bf16 v99, v116, v44, 0
  v_dot2_f32_bf16 v99, v117, v45, v99
  v_dot2_f32_bf16 v99, v118, v46, v99
  v_dot2_f32_bf16 v99, v119, v47, v99
  ds_read_b128 v[152:155], v7 offset:128
  ds_read_b128 v[156:159], v7 offset:2432
  s_waitcnt lgkmcnt(15)
  v_dot2_f32_bf16 v100, v116, v48, 0
  v_dot2_f32_bf16 v100, v117, v49, v100
  v_dot2_f32_bf16 v100, v118, v50, v100
  v_dot2_f32_bf16 v100, v119, v51, v100
  ds_read_b128 v[160:163], v7 offset:96
  ds_read_b128 v[164:167], v7 offset:2400
  v_dot2_f32_bf16 v101, v116, v52, 0
  v_dot2_f32_bf16 v101, v117, v53, v101
  v_dot2_f32_bf16 v101, v118, v54, v101
  v_dot2_f32_bf16 v101, v119, v55, v101
  ds_read_b128 v[168:171], v7 offset:64
  ds_read_b128 v[172:175], v7 offset:2368
  v_dot2_f32_bf16 v102, v116, v56, 0
  v_dot2_f32_bf16 v102, v117, v57, v102
  v_dot2_f32_bf16 v102, v118, v58, v102
  v_dot2_f32_bf16 v102, v119, v59, v102
  ds_read_b128 v[176:179], v7 offset:32
  ds_read_b128 v[180:183], v7 offset:2336
  v_dot2_f32_bf16 v103, v116, v60, 0
  v_dot2_f32_bf16 v103, v117, v61, v103
  v_dot2_f32_bf16 v103, v118, v62, v103
  v_dot2_f32_bf16 v103, v119, v63, v103
  ds_read_b128 v[184:187], v7 offset:0
  ds_read_b128 v[188:191], v7 offset:2304
  s_waitcnt lgkmcnt(15)
  v_dot2_f32_bf16 v104, v120, v64, 0
  v_dot2_f32_bf16 v104, v121, v65, v104
  v_dot2_f32_bf16 v104, v122, v66, v104
  v_dot2_f32_bf16 v104, v123, v67, v104
  ds_read_b128 v[192:195], v7 offset:9440
  ds_read_b128 v[196:199], v7 offset:11744
  v_dot2_f32_bf16 v105, v120, v68, 0
  v_dot2_f32_bf16 v105, v121, v69, v105
  v_dot2_f32_bf16 v105, v122, v70, v105
  v_dot2_f32_bf16 v105, v123, v71, v105
  ds_read_b128 v[200:203], v7 offset:9408
  ds_read_b128 v[204:207], v7 offset:11712
  v_dot2_f32_bf16 v106, v120, v72, 0
  v_dot2_f32_bf16 v106, v121, v73, v106
  v_dot2_f32_bf16 v106, v122, v74, v106
  v_dot2_f32_bf16 v106, v123, v75, v106
  ds_read_b128 v[208:211], v7 offset:9376
  ds_read_b128 v[212:215], v7 offset:11680
  v_dot2_f32_bf16 v107, v120, v76, 0
  v_dot2_f32_bf16 v107, v121, v77, v107
  v_dot2_f32_bf16 v107, v122, v78, v107
  v_dot2_f32_bf16 v107, v123, v79, v107
  ds_read_b128 v[216:219], v7 offset:9344
  ds_read_b128 v[220:223], v7 offset:11648
  s_waitcnt lgkmcnt(15)
  v_dot2_f32_bf16 v108, v120, v80, 0
  v_dot2_f32_bf16 v108, v121, v81, v108
  v_dot2_f32_bf16 v108, v122, v82, v108
  v_dot2_f32_bf16 v108, v123, v83, v108
  ds_read_b128 v[224:227], v7 offset:9312
  ds_read_b128 v[228:231], v7 offset:11616
  v_dot2_f32_bf16 v109, v120, v84, 0
  v_dot2_f32_bf16 v109, v121, v85, v109
  v_dot2_f32_bf16 v109, v122, v86, v109
  v_dot2_f32_bf16 v109, v123, v87, v109
  ds_read_b128 v[232:235], v7 offset:9280
  ds_read_b128 v[236:239], v7 offset:11584
  v_dot2_f32_bf16 v110, v120, v88, 0
  v_dot2_f32_bf16 v110, v121, v89, v110
  v_dot2_f32_bf16 v110, v122, v90, v110
  v_dot2_f32_bf16 v110, v123, v91, v110
  ds_read_b128 v[240:243], v7 offset:9248
  ds_read_b128 v[244:247], v7 offset:11552
  v_dot2_f32_bf16 v111, v120, v92, 0
  v_dot2_f32_bf16 v111, v121, v93, v111
  v_dot2_f32_bf16 v111, v122, v94, v111
  v_dot2_f32_bf16 v111, v123, v95, v111
  ds_read_b128 v[248:251], v7 offset:9216
  ds_read_b128 v[252:255], v7 offset:11520
  v_permlane32_swap_b32 v96, v104
  v_permlane32_swap_b32 v97, v105
  v_permlane32_swap_b32 v98, v106
  v_permlane32_swap_b32 v99, v107
  v_permlane32_swap_b32 v100, v108
  v_permlane32_swap_b32 v101, v109
  v_permlane32_swap_b32 v102, v110
  v_permlane32_swap_b32 v103, v111
  v_add_f32 v96, v96, v104
  v_add_f32 v97, v97, v105
  v_add_f32 v98, v98, v106
  v_add_f32 v99, v99, v107
  v_add_f32 v100, v100, v108
  v_add_f32 v101, v101, v109
  v_add_f32 v102, v102, v110
  v_add_f32 v103, v103, v111
  v_cvt_pk_bf16_f32 v5, v96, v97
  v_lshlrev_b32 v96, 16, v5
  v_and_b32 v97, 0xffff0000, v5
  v_cvt_pk_bf16_f32 v5, v98, v99
  v_lshlrev_b32 v98, 16, v5
  v_and_b32 v99, 0xffff0000, v5
  v_cvt_pk_bf16_f32 v5, v100, v101
  v_lshlrev_b32 v100, 16, v5
  v_and_b32 v101, 0xffff0000, v5
  v_cvt_pk_bf16_f32 v5, v102, v103
  v_lshlrev_b32 v102, 16, v5
  v_and_b32 v103, 0xffff0000, v5
  s_mov_b32 s35, 0x3eb8aa3b
  s_cmp_lg_u32 s36, 0
  s_cbranch_scc1 P1_NOMASK
  v_and_b32 v3, 31, v2
  v_mov_b32 v4, 0xcf6e6b28
  v_cmp_le_u32 vcc, 2, v3
  s_nop 1
  v_cndmask_b32 v97, v4, v97, vcc
  v_cmp_le_u32 vcc, 4, v3
  s_nop 1
  v_cndmask_b32 v98, v4, v98, vcc
  v_cmp_le_u32 vcc, 6, v3
  s_nop 1
  v_cndmask_b32 v99, v4, v99, vcc
  v_cmp_le_u32 vcc, 8, v3
  s_nop 1
  v_cndmask_b32 v100, v4, v100, vcc
  v_cmp_le_u32 vcc, 10, v3
  s_nop 1
  v_cndmask_b32 v101, v4, v101, vcc
  v_cmp_le_u32 vcc, 12, v3
  s_nop 1
  v_cndmask_b32 v102, v4, v102, vcc
  v_cmp_le_u32 vcc, 14, v3
  s_nop 1
  v_cndmask_b32 v103, v4, v103, vcc
P1_NOMASK:
  v_max3_f32 v5, v96, v97, v98
  v_max3_f32 v6, v99, v100, v101
  v_max3_f32 v5, v5, v102, v103
  v_max_f32 v5, v5, v6
  v_sub_f32 v96, v96, v5
  v_sub_f32 v97, v97, v5
  v_sub_f32 v98, v98, v5
  v_sub_f32 v99, v99, v5
  v_sub_f32 v100, v100, v5
  v_sub_f32 v101, v101, v5
  v_sub_f32 v102, v102, v5
  v_sub_f32 v103, v103, v5
  v_mul_f32 v96, s35, v96
  v_mul_f32 v97, s35, v97
  v_mul_f32 v98, s35, v98
  v_mul_f32 v99, s35, v99
  v_mul_f32 v100, s35, v100
  v_mul_f32 v101, s35, v101
  v_mul_f32 v102, s35, v102
  v_mul_f32 v103, s35, v103
  v_exp_f32 v96, v96
  v_exp_f32 v97, v97
  v_exp_f32 v98, v98
  v_exp_f32 v99, v99
  v_exp_f32 v100, v100
  v_exp_f32 v101, v101
  v_exp_f32 v102, v102
  v_exp_f32 v103, v103
  v_add_f32 v5, v96, v97
  v_add_f32 v6, v98, v99
  v_add_f32 v9, v100, v101
  v_add_f32 v10, v102, v103
  v_add_f32 v5, v5, v6
  v_add_f32 v9, v9, v10
  v_add_f32 v6, v5, v9
  v_rcp_f32 v6, v6
  s_nop 0
  v_mul_f32 v96, v96, v6
  v_mul_f32 v97, v97, v6
  v_mul_f32 v98, v98, v6
  v_mul_f32 v99, v99, v6
  v_mul_f32 v100, v100, v6
  v_mul_f32 v101, v101, v6
  v_mul_f32 v102, v102, v6
  v_mul_f32 v103, v103, v6
  v_cvt_pk_bf16_f32 v5, v96, v97
  v_lshlrev_b32 v96, 16, v5
  v_and_b32 v97, 0xffff0000, v5
  v_cvt_pk_bf16_f32 v5, v98, v99
  v_lshlrev_b32 v98, 16, v5
  v_and_b32 v99, 0xffff0000, v5
  v_cvt_pk_bf16_f32 v5, v100, v101
  v_lshlrev_b32 v100, 16, v5
  v_and_b32 v101, 0xffff0000, v5
  v_cvt_pk_bf16_f32 v5, v102, v103
  v_lshlrev_b32 v102, 16, v5
  v_and_b32 v103, 0xffff0000, v5
  v_mov_b32 v104, v96
  v_mov_b32 v105, v97
  v_mov_b32 v106, v98
  v_mov_b32 v107, v99
  v_mov_b32 v108, v100
  v_mov_b32 v109, v101
  v_mov_b32 v110, v102
  v_mov_b32 v111, v103
  v_permlane32_swap_b32 v96, v104
  v_permlane32_swap_b32 v97, v105
  v_permlane32_swap_b32 v98, v106
  v_permlane32_swap_b32 v99, v107
  v_permlane32_swap_b32 v100, v108
  v_permlane32_swap_b32 v101, v109
  v_permlane32_swap_b32 v102, v110
  v_permlane32_swap_b32 v103, v111
  s_lshl_b32 s37, s36, 15
  s_lshl_b32 s38, s34, 11
  s_add_u32 s37, s37, s38
  s_add_u32 s37, s37, 5242880
  s_waitcnt lgkmcnt(15)
  v_mul_f32 v16, v96, v128
  v_mul_f32 v17, v96, v129
  v_mul_f32 v18, v96, v130
  v_mul_f32 v19, v96, v131
  v_mul_f32 v20, v96, v132
  v_mul_f32 v21, v96, v133
  v_mul_f32 v22, v96, v134
  v_mul_f32 v23, v96, v135
  v_fmac_f32 v16, v97, v136
  v_fmac_f32 v17, v97, v137
  v_fmac_f32 v18, v97, v138
  v_fmac_f32 v19, v97, v139
  v_fmac_f32 v20, v97, v140
  v_fmac_f32 v21, v97, v141
  v_fmac_f32 v22, v97, v142
  v_fmac_f32 v23, v97, v143
  s_waitcnt lgkmcnt(15)
  v_fmac_f32 v16, v98, v144
  v_fmac_f32 v17, v98, v145
  v_fmac_f32 v18, v98, v146
  v_fmac_f32 v19, v98, v147
  v_fmac_f32 v20, v98, v148
  v_fmac_f32 v21, v98, v149
  v_fmac_f32 v22, v98, v150
  v_fmac_f32 v23, v98, v151
  v_fmac_f32 v16, v99, v152
  v_fmac_f32 v17, v99, v153
  v_fmac_f32 v18, v99, v154
  v_fmac_f32 v19, v99, v155
  v_fmac_f32 v20, v99, v156
  v_fmac_f32 v21, v99, v157
  v_fmac_f32 v22, v99, v158
  v_fmac_f32 v23, v99, v159
  s_waitcnt lgkmcnt(15)
  v_fmac_f32 v16, v100, v160
  v_fmac_f32 v17, v100, v161
  v_fmac_f32 v18, v100, v162
  v_fmac_f32 v19, v100, v163
  v_fmac_f32 v20, v100, v164
  v_fmac_f32 v21, v100, v165
  v_fmac_f32 v22, v100, v166
  v_fmac_f32 v23, v100, v167
  v_fmac_f32 v16, v101, v168
  v_fmac_f32 v17, v101, v169
  v_fmac_f32 v18, v101, v170
  v_fmac_f32 v19, v101, v171
  v_fmac_f32 v20, v101, v172
  v_fmac_f32 v21, v101, v173
  v_fmac_f32 v22, v101, v174
  v_fmac_f32 v23, v101, v175
  s_waitcnt lgkmcnt(15)
  v_fmac_f32 v16, v102, v176
  v_fmac_f32 v17, v102, v177
  v_fmac_f32 v18, v102, v178
  v_fmac_f32 v19, v102, v179
  v_fmac_f32 v20, v102, v180
  v_fmac_f32 v21, v102, v181
  v_fmac_f32 v22, v102, v182
  v_fmac_f32 v23, v102, v183
  v_fmac_f32 v16, v103, v184
  v_fmac_f32 v17, v103, v185
  v_fmac_f32 v18, v103, v186
  v_fmac_f32 v19, v103, v187
  v_fmac_f32 v20, v103, v188
  v_fmac_f32 v21, v103, v189
  v_fmac_f32 v22, v103, v190
  v_fmac_f32 v23, v103, v191
  v_cvt_pk_bf16_f32 v32, v16, v17
  v_cvt_pk_bf16_f32 v33, v18, v19
  v_cvt_pk_bf16_f32 v34, v20, v21
  v_cvt_pk_bf16_f32 v35, v22, v23
  buffer_store_dwordx4 v[32:35], v8, s[8:11], s37 offen offset:0 sc1
  s_waitcnt lgkmcnt(12)
  v_mul_f32 v16, v104, v192
  v_mul_f32 v17, v104, v193
  v_mul_f32 v18, v104, v194
  v_mul_f32 v19, v104, v195
  v_mul_f32 v20, v104, v196
  v_mul_f32 v21, v104, v197
  v_mul_f32 v22, v104, v198
  v_mul_f32 v23, v104, v199
  v_fmac_f32 v16, v105, v200
  v_fmac_f32 v17, v105, v201
  v_fmac_f32 v18, v105, v202
  v_fmac_f32 v19, v105, v203
  v_fmac_f32 v20, v105, v204
  v_fmac_f32 v21, v105, v205
  v_fmac_f32 v22, v105, v206
  v_fmac_f32 v23, v105, v207
  s_waitcnt lgkmcnt(8)
  v_fmac_f32 v16, v106, v208
  v_fmac_f32 v17, v106, v209
  v_fmac_f32 v18, v106, v210
  v_fmac_f32 v19, v106, v211
  v_fmac_f32 v20, v106, v212
  v_fmac_f32 v21, v106, v213
  v_fmac_f32 v22, v106, v214
  v_fmac_f32 v23, v106, v215
  v_fmac_f32 v16, v107, v216
  v_fmac_f32 v17, v107, v217
  v_fmac_f32 v18, v107, v218
  v_fmac_f32 v19, v107, v219
  v_fmac_f32 v20, v107, v220
  v_fmac_f32 v21, v107, v221
  v_fmac_f32 v22, v107, v222
  v_fmac_f32 v23, v107, v223
  s_waitcnt lgkmcnt(4)
  v_fmac_f32 v16, v108, v224
  v_fmac_f32 v17, v108, v225
  v_fmac_f32 v18, v108, v226
  v_fmac_f32 v19, v108, v227
  v_fmac_f32 v20, v108, v228
  v_fmac_f32 v21, v108, v229
  v_fmac_f32 v22, v108, v230
  v_fmac_f32 v23, v108, v231
  v_fmac_f32 v16, v109, v232
  v_fmac_f32 v17, v109, v233
  v_fmac_f32 v18, v109, v234
  v_fmac_f32 v19, v109, v235
  v_fmac_f32 v20, v109, v236
  v_fmac_f32 v21, v109, v237
  v_fmac_f32 v22, v109, v238
  v_fmac_f32 v23, v109, v239
  s_waitcnt lgkmcnt(0)
  v_fmac_f32 v16, v110, v240
  v_fmac_f32 v17, v110, v241
  v_fmac_f32 v18, v110, v242
  v_fmac_f32 v19, v110, v243
  v_fmac_f32 v20, v110, v244
  v_fmac_f32 v21, v110, v245
  v_fmac_f32 v22, v110, v246
  v_fmac_f32 v23, v110, v247
  v_fmac_f32 v16, v111, v248
  v_fmac_f32 v17, v111, v249
  v_fmac_f32 v18, v111, v250
  v_fmac_f32 v19, v111, v251
  v_fmac_f32 v20, v111, v252
  v_fmac_f32 v21, v111, v253
  v_fmac_f32 v22, v111, v254
  v_fmac_f32 v23, v111, v255
  v_cvt_pk_bf16_f32 v36, v16, v17
  v_cvt_pk_bf16_f32 v37, v18, v19
  v_cvt_pk_bf16_f32 v38, v20, v21
  v_cvt_pk_bf16_f32 v39, v22, v23
  buffer_store_dwordx4 v[36:39], v8, s[8:11], s37 offen offset:1024 sc1
  s_lshl_b32 s38, s36, 8
  s_add_u32 s38, s38, 196608
  s_waitcnt vmcnt(0)
  v_mov_b32 v0, 0
  v_mov_b32 v1, 1
  s_mov_b64 exec, 1
  buffer_atomic_add v1, v0, s[8:11], s38 offen sc1
  s_mov_b64 exec, -1
  s_bfe_u32 s33, s2, 0x20001
  s_lshl_b32 s33, s33, 3
  s_bfe_u32 s34, s2, 0x30003
  s_add_u32 s33, s33, s34
  s_and_b32 s34, s2, 1
  s_lshl_b32 s34, s34, 2
  s_lshr_b32 s35, s2, 6
  s_add_u32 s34, s34, s35
  s_and_b32 s51, s3, 1
  s_lshr_b32 s52, s3, 1
  s_lshl_b32 s36, s33, 1
  s_add_u32 s36, s36, s51
  s_lshl_b32 s35, s34, 1
  s_add_u32 s35, s35, s52
  v_and_b32 v3, 31, v2
  v_lshrrev_b32 v4, 5, v2
  v_lshlrev_b32 v5, 4, v4
  s_lshl_b32 s41, s36, 15
  s_lshl_b32 s42, s35, 6
  s_add_u32 s41, s41, s42
  v_lshlrev_b32 v6, 10, v3
  v_lshl_add_u32 v6, v4, 3, v6
  s_lshl_b32 s42, s36, 15
  s_lshl_b32 s44, s35, 11
  s_add_u32 s42, s42, s44
  s_add_u32 s42, s42, 8388608
  s_lshl_b32 s43, s35, 7
  s_add_u32 s43, s43, 4096
  buffer_load_dwordx4 v[128:131], v5, s[8:11], s43 offen offset:0
  buffer_load_dwordx4 v[132:135], v5, s[8:11], s43 offen offset:32
  buffer_load_dwordx4 v[136:139], v5, s[8:11], s43 offen offset:64
  buffer_load_dwordx4 v[140:143], v5, s[8:11], s43 offen offset:96
  s_lshl_b32 s43, s35, 7
  s_add_u32 s43, s43, 16384
  buffer_load_dwordx4 v[144:147], v5, s[8:11], s43 offen offset:0
  buffer_load_dwordx4 v[148:151], v5, s[8:11], s43 offen offset:32
  buffer_load_dwordx4 v[152:155], v5, s[8:11], s43 offen offset:64
  buffer_load_dwordx4 v[156:159], v5, s[8:11], s43 offen offset:96
  s_lshl_b32 s43, s35, 7
  s_add_u32 s43, s43, 28672
  buffer_load_dwordx4 v[160:163], v5, s[8:11], s43 offen offset:0
  buffer_load_dwordx4 v[164:167], v5, s[8:11], s43 offen offset:32
  buffer_load_dwordx4 v[168:171], v5, s[8:11], s43 offen offset:64
  buffer_load_dwordx4 v[172:175], v5, s[8:11], s43 offen offset:96
  s_lshl_b32 s43, s35, 7
  s_add_u32 s43, s43, 40960
  buffer_load_dwordx4 v[176:179], v5, s[8:11], s43 offen offset:0
  buffer_load_dwordx4 v[180:183], v5, s[8:11], s43 offen offset:32
  buffer_load_dwordx4 v[184:187], v5, s[8:11], s43 offen offset:64
  buffer_load_dwordx4 v[188:191], v5, s[8:11], s43 offen offset:96
  s_lshl_b32 s43, s35, 7
  s_add_u32 s43, s43, 8192
  buffer_load_dwordx4 v[192:195], v5, s[8:11], s43 offen offset:0
  buffer_load_dwordx4 v[196:199], v5, s[8:11], s43 offen offset:32
  buffer_load_dwordx4 v[200:203], v5, s[8:11], s43 offen offset:64
  buffer_load_dwordx4 v[204:207], v5, s[8:11], s43 offen offset:96
  s_lshl_b32 s43, s35, 7
  s_add_u32 s43, s43, 20480
  buffer_load_dwordx4 v[208:211], v5, s[8:11], s43 offen offset:0
  buffer_load_dwordx4 v[212:215], v5, s[8:11], s43 offen offset:32
  buffer_load_dwordx4 v[216:219], v5, s[8:11], s43 offen offset:64
  buffer_load_dwordx4 v[220:223], v5, s[8:11], s43 offen offset:96
  s_lshl_b32 s43, s35, 7
  s_add_u32 s43, s43, 32768
  buffer_load_dwordx4 v[224:227], v5, s[8:11], s43 offen offset:0
  buffer_load_dwordx4 v[228:231], v5, s[8:11], s43 offen offset:32
  buffer_load_dwordx4 v[232:235], v5, s[8:11], s43 offen offset:64
  buffer_load_dwordx4 v[236:239], v5, s[8:11], s43 offen offset:96
  s_lshl_b32 s43, s35, 7
  s_add_u32 s43, s43, 45056
  buffer_load_dwordx4 v[240:243], v5, s[8:11], s43 offen offset:0
  buffer_load_dwordx4 v[244:247], v5, s[8:11], s43 offen offset:32
  buffer_load_dwordx4 v[248:251], v5, s[8:11], s43 offen offset:64
  buffer_load_dwordx4 v[252:255], v5, s[8:11], s43 offen offset:96
  buffer_load_dwordx2 v[32:33], v6, s[12:15], s41 offen offset:0
  buffer_load_dwordx2 v[34:35], v6, s[12:15], s41 offen offset:16
  buffer_load_dwordx2 v[36:37], v6, s[12:15], s41 offen offset:32
  buffer_load_dwordx2 v[38:39], v6, s[12:15], s41 offen offset:48
  s_lshl_b32 s44, s52, 15
  v_add_u32 v10, s44, v8
  s_lshl_b32 s44, s51, 15
  s_add_u32 s44, s44, 65536
  v_add_u32 v9, s44, v8
  s_waitcnt vmcnt(0)
  v_add_f32 v128, v128, v144
  v_add_f32 v160, v160, v176
  v_add_f32 v16, v128, v160
  v_add_f32 v129, v129, v145
  v_add_f32 v161, v161, v177
  v_add_f32 v17, v129, v161
  v_add_f32 v130, v130, v146
  v_add_f32 v162, v162, v178
  v_add_f32 v18, v130, v162
  v_add_f32 v131, v131, v147
  v_add_f32 v163, v163, v179
  v_add_f32 v19, v131, v163
  v_add_f32 v132, v132, v148
  v_add_f32 v164, v164, v180
  v_add_f32 v20, v132, v164
  v_add_f32 v133, v133, v149
  v_add_f32 v165, v165, v181
  v_add_f32 v21, v133, v165
  v_add_f32 v134, v134, v150
  v_add_f32 v166, v166, v182
  v_add_f32 v22, v134, v166
  v_add_f32 v135, v135, v151
  v_add_f32 v167, v167, v183
  v_add_f32 v23, v135, v167
  v_add_f32 v136, v136, v152
  v_add_f32 v168, v168, v184
  v_add_f32 v24, v136, v168
  v_add_f32 v137, v137, v153
  v_add_f32 v169, v169, v185
  v_add_f32 v25, v137, v169
  v_add_f32 v138, v138, v154
  v_add_f32 v170, v170, v186
  v_add_f32 v26, v138, v170
  v_add_f32 v139, v139, v155
  v_add_f32 v171, v171, v187
  v_add_f32 v27, v139, v171
  v_add_f32 v140, v140, v156
  v_add_f32 v172, v172, v188
  v_add_f32 v28, v140, v172
  v_add_f32 v141, v141, v157
  v_add_f32 v173, v173, v189
  v_add_f32 v29, v141, v173
  v_add_f32 v142, v142, v158
  v_add_f32 v174, v174, v190
  v_add_f32 v30, v142, v174
  v_add_f32 v143, v143, v159
  v_add_f32 v175, v175, v191
  v_add_f32 v31, v143, v175
  v_cvt_pk_bf16_f32 v1, v16, v17
  v_lshlrev_b32 v16, 16, v1
  v_and_b32 v17, 0xffff0000, v1
  v_cvt_pk_bf16_f32 v1, v18, v19
  v_lshlrev_b32 v18, 16, v1
  v_and_b32 v19, 0xffff0000, v1
  v_cvt_pk_bf16_f32 v1, v20, v21
  v_lshlrev_b32 v20, 16, v1
  v_and_b32 v21, 0xffff0000, v1
  v_cvt_pk_bf16_f32 v1, v22, v23
  v_lshlrev_b32 v22, 16, v1
  v_and_b32 v23, 0xffff0000, v1
  v_cvt_pk_bf16_f32 v1, v24, v25
  v_lshlrev_b32 v24, 16, v1
  v_and_b32 v25, 0xffff0000, v1
  v_cvt_pk_bf16_f32 v1, v26, v27
  v_lshlrev_b32 v26, 16, v1
  v_and_b32 v27, 0xffff0000, v1
  v_cvt_pk_bf16_f32 v1, v28, v29
  v_lshlrev_b32 v28, 16, v1
  v_and_b32 v29, 0xffff0000, v1
  v_cvt_pk_bf16_f32 v1, v30, v31
  v_lshlrev_b32 v30, 16, v1
  v_and_b32 v31, 0xffff0000, v1
  v_add_f32 v192, v192, v208
  v_add_f32 v224, v224, v240
  v_add_f32 v112, v192, v224
  v_add_f32 v193, v193, v209
  v_add_f32 v225, v225, v241
  v_add_f32 v113, v193, v225
  v_add_f32 v194, v194, v210
  v_add_f32 v226, v226, v242
  v_add_f32 v114, v194, v226
  v_add_f32 v195, v195, v211
  v_add_f32 v227, v227, v243
  v_add_f32 v115, v195, v227
  v_add_f32 v196, v196, v212
  v_add_f32 v228, v228, v244
  v_add_f32 v116, v196, v228
  v_add_f32 v197, v197, v213
  v_add_f32 v229, v229, v245
  v_add_f32 v117, v197, v229
  v_add_f32 v198, v198, v214
  v_add_f32 v230, v230, v246
  v_add_f32 v118, v198, v230
  v_add_f32 v199, v199, v215
  v_add_f32 v231, v231, v247
  v_add_f32 v119, v199, v231
  v_add_f32 v200, v200, v216
  v_add_f32 v232, v232, v248
  v_add_f32 v120, v200, v232
  v_add_f32 v201, v201, v217
  v_add_f32 v233, v233, v249
  v_add_f32 v121, v201, v233
  v_add_f32 v202, v202, v218
  v_add_f32 v234, v234, v250
  v_add_f32 v122, v202, v234
  v_add_f32 v203, v203, v219
  v_add_f32 v235, v235, v251
  v_add_f32 v123, v203, v235
  v_add_f32 v204, v204, v220
  v_add_f32 v236, v236, v252
  v_add_f32 v124, v204, v236
  v_add_f32 v205, v205, v221
  v_add_f32 v237, v237, v253
  v_add_f32 v125, v205, v237
  v_add_f32 v206, v206, v222
  v_add_f32 v238, v238, v254
  v_add_f32 v126, v206, v238
  v_add_f32 v207, v207, v223
  v_add_f32 v239, v239, v255
  v_add_f32 v127, v207, v239
  v_cvt_pk_bf16_f32 v1, v112, v113
  v_lshlrev_b32 v112, 16, v1
  v_and_b32 v113, 0xffff0000, v1
  v_cvt_pk_bf16_f32 v1, v114, v115
  v_lshlrev_b32 v114, 16, v1
  v_and_b32 v115, 0xffff0000, v1
  v_cvt_pk_bf16_f32 v1, v116, v117
  v_lshlrev_b32 v116, 16, v1
  v_and_b32 v117, 0xffff0000, v1
  v_cvt_pk_bf16_f32 v1, v118, v119
  v_lshlrev_b32 v118, 16, v1
  v_and_b32 v119, 0xffff0000, v1
  v_cvt_pk_bf16_f32 v1, v120, v121
  v_lshlrev_b32 v120, 16, v1
  v_and_b32 v121, 0xffff0000, v1
  v_cvt_pk_bf16_f32 v1, v122, v123
  v_lshlrev_b32 v122, 16, v1
  v_and_b32 v123, 0xffff0000, v1
  v_cvt_pk_bf16_f32 v1, v124, v125
  v_lshlrev_b32 v124, 16, v1
  v_and_b32 v125, 0xffff0000, v1
  v_cvt_pk_bf16_f32 v1, v126, v127
  v_lshlrev_b32 v126, 16, v1
  v_and_b32 v127, 0xffff0000, v1
  v_add_f32 v112, 1.0, v112
  v_add_f32 v113, 1.0, v113
  v_add_f32 v114, 1.0, v114
  v_add_f32 v115, 1.0, v115
  v_add_f32 v116, 1.0, v116
  v_add_f32 v117, 1.0, v117
  v_add_f32 v118, 1.0, v118
  v_add_f32 v119, 1.0, v119
  v_add_f32 v120, 1.0, v120
  v_add_f32 v121, 1.0, v121
  v_add_f32 v122, 1.0, v122
  v_add_f32 v123, 1.0, v123
  v_add_f32 v124, 1.0, v124
  v_add_f32 v125, 1.0, v125
  v_add_f32 v126, 1.0, v126
  v_add_f32 v127, 1.0, v127
  v_cvt_pk_bf16_f32 v1, v112, v113
  v_lshlrev_b32 v112, 16, v1
  v_and_b32 v113, 0xffff0000, v1
  v_cvt_pk_bf16_f32 v1, v114, v115
  v_lshlrev_b32 v114, 16, v1
  v_and_b32 v115, 0xffff0000, v1
  v_cvt_pk_bf16_f32 v1, v116, v117
  v_lshlrev_b32 v116, 16, v1
  v_and_b32 v117, 0xffff0000, v1
  v_cvt_pk_bf16_f32 v1, v118, v119
  v_lshlrev_b32 v118, 16, v1
  v_and_b32 v119, 0xffff0000, v1
  v_cvt_pk_bf16_f32 v1, v120, v121
  v_lshlrev_b32 v120, 16, v1
  v_and_b32 v121, 0xffff0000, v1
  v_cvt_pk_bf16_f32 v1, v122, v123
  v_lshlrev_b32 v122, 16, v1
  v_and_b32 v123, 0xffff0000, v1
  v_cvt_pk_bf16_f32 v1, v124, v125
  v_lshlrev_b32 v124, 16, v1
  v_and_b32 v125, 0xffff0000, v1
  v_cvt_pk_bf16_f32 v1, v126, v127
  v_lshlrev_b32 v126, 16, v1
  v_and_b32 v127, 0xffff0000, v1
  s_barrier
  ds_read_b128 v[64:67], v10 offset:0
  ds_read_b128 v[68:71], v9 offset:0
  ds_read_b128 v[72:75], v10 offset:1024
  ds_read_b128 v[76:79], v9 offset:1024
  ds_read_b128 v[80:83], v10 offset:2048
  ds_read_b128 v[84:87], v9 offset:2048
  ds_read_b128 v[88:91], v10 offset:3072
  ds_read_b128 v[92:95], v9 offset:3072
  s_waitcnt lgkmcnt(6)
  v_mfma_f32_32x32x16_bf16 v[48:63], v[64:67], v[68:71], 0
  ds_read_b128 v[64:67], v10 offset:4096
  ds_read_b128 v[68:71], v9 offset:4096
  s_waitcnt lgkmcnt(6)
  v_mfma_f32_32x32x16_bf16 v[48:63], v[72:75], v[76:79], v[48:63]
  ds_read_b128 v[72:75], v10 offset:5120
  ds_read_b128 v[76:79], v9 offset:5120
  s_waitcnt lgkmcnt(6)
  v_mfma_f32_32x32x16_bf16 v[48:63], v[80:83], v[84:87], v[48:63]
  ds_read_b128 v[80:83], v10 offset:6144
  ds_read_b128 v[84:87], v9 offset:6144
  s_waitcnt lgkmcnt(6)
  v_mfma_f32_32x32x16_bf16 v[48:63], v[88:91], v[92:95], v[48:63]
  ds_read_b128 v[88:91], v10 offset:7168
  ds_read_b128 v[92:95], v9 offset:7168
  s_waitcnt lgkmcnt(6)
  v_mfma_f32_32x32x16_bf16 v[48:63], v[64:67], v[68:71], v[48:63]
  s_barrier
  ds_read_b128 v[64:67], v10 offset:8192
  ds_read_b128 v[68:71], v9 offset:8192
  s_waitcnt lgkmcnt(6)
  v_mfma_f32_32x32x16_bf16 v[48:63], v[72:75], v[76:79], v[48:63]
  ds_read_b128 v[72:75], v10 offset:9216
  ds_read_b128 v[76:79], v9 offset:9216
  s_waitcnt lgkmcnt(6)
  v_mfma_f32_32x32x16_bf16 v[48:63], v[80:83], v[84:87], v[48:63]
  ds_read_b128 v[80:83], v10 offset:10240
  ds_read_b128 v[84:87], v9 offset:10240
  s_waitcnt lgkmcnt(6)
  v_mfma_f32_32x32x16_bf16 v[48:63], v[88:91], v[92:95], v[48:63]
  ds_read_b128 v[88:91], v10 offset:11264
  ds_read_b128 v[92:95], v9 offset:11264
  s_waitcnt lgkmcnt(6)
  v_mfma_f32_32x32x16_bf16 v[48:63], v[64:67], v[68:71], v[48:63]
  ds_read_b128 v[64:67], v10 offset:12288
  ds_read_b128 v[68:71], v9 offset:12288
  s_waitcnt lgkmcnt(6)
  v_mfma_f32_32x32x16_bf16 v[48:63], v[72:75], v[76:79], v[48:63]
  ds_read_b128 v[72:75], v10 offset:13312
  ds_read_b128 v[76:79], v9 offset:13312
  s_waitcnt lgkmcnt(6)
  v_mfma_f32_32x32x16_bf16 v[48:63], v[80:83], v[84:87], v[48:63]
  ds_read_b128 v[80:83], v10 offset:14336
  ds_read_b128 v[84:87], v9 offset:14336
  s_waitcnt lgkmcnt(6)
  v_mfma_f32_32x32x16_bf16 v[48:63], v[88:91], v[92:95], v[48:63]
  ds_read_b128 v[88:91], v10 offset:15360
  ds_read_b128 v[92:95], v9 offset:15360
  s_waitcnt lgkmcnt(6)
  v_mfma_f32_32x32x16_bf16 v[48:63], v[64:67], v[68:71], v[48:63]
  s_barrier
  ds_read_b128 v[64:67], v10 offset:16384
  ds_read_b128 v[68:71], v9 offset:16384
  s_waitcnt lgkmcnt(6)
  v_mfma_f32_32x32x16_bf16 v[48:63], v[72:75], v[76:79], v[48:63]
  ds_read_b128 v[72:75], v10 offset:17408
  ds_read_b128 v[76:79], v9 offset:17408
  s_waitcnt lgkmcnt(6)
  v_mfma_f32_32x32x16_bf16 v[48:63], v[80:83], v[84:87], v[48:63]
  ds_read_b128 v[80:83], v10 offset:18432
  ds_read_b128 v[84:87], v9 offset:18432
  s_waitcnt lgkmcnt(6)
  v_mfma_f32_32x32x16_bf16 v[48:63], v[88:91], v[92:95], v[48:63]
  ds_read_b128 v[88:91], v10 offset:19456
  ds_read_b128 v[92:95], v9 offset:19456
  s_waitcnt lgkmcnt(6)
  v_mfma_f32_32x32x16_bf16 v[48:63], v[64:67], v[68:71], v[48:63]
  ds_read_b128 v[64:67], v10 offset:20480
  ds_read_b128 v[68:71], v9 offset:20480
  s_waitcnt lgkmcnt(6)
  v_mfma_f32_32x32x16_bf16 v[48:63], v[72:75], v[76:79], v[48:63]
  ds_read_b128 v[72:75], v10 offset:21504
  ds_read_b128 v[76:79], v9 offset:21504
  s_waitcnt lgkmcnt(6)
  v_mfma_f32_32x32x16_bf16 v[48:63], v[80:83], v[84:87], v[48:63]
  ds_read_b128 v[80:83], v10 offset:22528
  ds_read_b128 v[84:87], v9 offset:22528
  s_waitcnt lgkmcnt(6)
  v_mfma_f32_32x32x16_bf16 v[48:63], v[88:91], v[92:95], v[48:63]
  ds_read_b128 v[88:91], v10 offset:23552
  ds_read_b128 v[92:95], v9 offset:23552
  s_waitcnt lgkmcnt(6)
  v_mfma_f32_32x32x16_bf16 v[48:63], v[64:67], v[68:71], v[48:63]
  s_barrier
  ds_read_b128 v[64:67], v10 offset:24576
  ds_read_b128 v[68:71], v9 offset:24576
  s_waitcnt lgkmcnt(6)
  v_mfma_f32_32x32x16_bf16 v[48:63], v[72:75], v[76:79], v[48:63]
  ds_read_b128 v[72:75], v10 offset:25600
  ds_read_b128 v[76:79], v9 offset:25600
  s_waitcnt lgkmcnt(6)
  v_mfma_f32_32x32x16_bf16 v[48:63], v[80:83], v[84:87], v[48:63]
  ds_read_b128 v[80:83], v10 offset:26624
  ds_read_b128 v[84:87], v9 offset:26624
  s_waitcnt lgkmcnt(6)
  v_mfma_f32_32x32x16_bf16 v[48:63], v[88:91], v[92:95], v[48:63]
  ds_read_b128 v[88:91], v10 offset:27648
  ds_read_b128 v[92:95], v9 offset:27648
  s_waitcnt lgkmcnt(6)
  v_mfma_f32_32x32x16_bf16 v[48:63], v[64:67], v[68:71], v[48:63]
  ds_read_b128 v[64:67], v10 offset:28672
  ds_read_b128 v[68:71], v9 offset:28672
  s_waitcnt lgkmcnt(6)
  v_mfma_f32_32x32x16_bf16 v[48:63], v[72:75], v[76:79], v[48:63]
  ds_read_b128 v[72:75], v10 offset:29696
  ds_read_b128 v[76:79], v9 offset:29696
  s_waitcnt lgkmcnt(6)
  v_mfma_f32_32x32x16_bf16 v[48:63], v[80:83], v[84:87], v[48:63]
  v_lshlrev_b32 v96, 16, v32
  v_and_b32 v97, 0xffff0000, v32
  v_lshlrev_b32 v98, 16, v33
  v_and_b32 v99, 0xffff0000, v33
  v_lshlrev_b32 v100, 16, v34
  v_and_b32 v101, 0xffff0000, v34
  v_lshlrev_b32 v102, 16, v35
  v_and_b32 v103, 0xffff0000, v35
  v_lshlrev_b32 v104, 16, v36
  v_and_b32 v105, 0xffff0000, v36
  v_lshlrev_b32 v106, 16, v37
  v_and_b32 v107, 0xffff0000, v37
  v_lshlrev_b32 v108, 16, v38
  v_and_b32 v109, 0xffff0000, v38
  v_lshlrev_b32 v110, 16, v39
  v_and_b32 v111, 0xffff0000, v39
  ds_read_b128 v[80:83], v10 offset:30720
  ds_read_b128 v[84:87], v9 offset:30720
  s_waitcnt lgkmcnt(6)
  v_mfma_f32_32x32x16_bf16 v[48:63], v[88:91], v[92:95], v[48:63]
  ds_read_b128 v[88:91], v10 offset:31744
  ds_read_b128 v[92:95], v9 offset:31744
  s_waitcnt lgkmcnt(6)
  v_mfma_f32_32x32x16_bf16 v[48:63], v[64:67], v[68:71], v[48:63]
  s_waitcnt lgkmcnt(4)
  v_mfma_f32_32x32x16_bf16 v[48:63], v[72:75], v[76:79], v[48:63]
  s_waitcnt lgkmcnt(2)
  v_mfma_f32_32x32x16_bf16 v[48:63], v[80:83], v[84:87], v[48:63]
  s_waitcnt lgkmcnt(0)
  v_mfma_f32_32x32x16_bf16 v[48:63], v[88:91], v[92:95], v[48:63]
  s_barrier
  s_nop 10
  v_fmac_f32 v96, v48, v16
  v_fmac_f32 v97, v49, v17
  v_fmac_f32 v98, v50, v18
  v_fmac_f32 v99, v51, v19
  v_fmac_f32 v100, v52, v20
  v_fmac_f32 v101, v53, v21
  v_fmac_f32 v102, v54, v22
  v_fmac_f32 v103, v55, v23
  v_fmac_f32 v104, v56, v24
  v_fmac_f32 v105, v57, v25
  v_fmac_f32 v106, v58, v26
  v_fmac_f32 v107, v59, v27
  v_fmac_f32 v108, v60, v28
  v_fmac_f32 v109, v61, v29
  v_fmac_f32 v110, v62, v30
  v_fmac_f32 v111, v63, v31
  v_cvt_pk_bf16_f32 v84, v96, v97
  v_cvt_pk_bf16_f32 v85, v98, v99
  v_cvt_pk_bf16_f32 v86, v100, v101
  v_cvt_pk_bf16_f32 v87, v102, v103
  v_cvt_pk_bf16_f32 v88, v104, v105
  v_cvt_pk_bf16_f32 v89, v106, v107
  v_cvt_pk_bf16_f32 v90, v108, v109
  v_cvt_pk_bf16_f32 v91, v110, v111
  v_lshlrev_b32 v96, 16, v84
  v_and_b32 v97, 0xffff0000, v84
  v_lshlrev_b32 v98, 16, v85
  v_and_b32 v99, 0xffff0000, v85
  v_lshlrev_b32 v100, 16, v86
  v_and_b32 v101, 0xffff0000, v86
  v_lshlrev_b32 v102, 16, v87
  v_and_b32 v103, 0xffff0000, v87
  v_lshlrev_b32 v104, 16, v88
  v_and_b32 v105, 0xffff0000, v88
  v_lshlrev_b32 v106, 16, v89
  v_and_b32 v107, 0xffff0000, v89
  v_lshlrev_b32 v108, 16, v90
  v_and_b32 v109, 0xffff0000, v90
  v_lshlrev_b32 v110, 16, v91
  v_and_b32 v111, 0xffff0000, v91
  v_mul_f32 v112, v112, v96
  v_mul_f32 v113, v113, v97
  v_mul_f32 v114, v114, v98
  v_mul_f32 v115, v115, v99
  v_mul_f32 v116, v116, v100
  v_mul_f32 v117, v117, v101
  v_mul_f32 v118, v118, v102
  v_mul_f32 v119, v119, v103
  v_mul_f32 v120, v120, v104
  v_mul_f32 v121, v121, v105
  v_mul_f32 v122, v122, v106
  v_mul_f32 v123, v123, v107
  v_mul_f32 v124, v124, v108
  v_mul_f32 v125, v125, v109
  v_mul_f32 v126, v126, v110
  v_mul_f32 v127, v127, v111
  v_cvt_pk_bf16_f32 v64, v112, v113
  v_cvt_pk_bf16_f32 v65, v114, v115
  v_cvt_pk_bf16_f32 v66, v116, v117
  v_cvt_pk_bf16_f32 v67, v118, v119
  v_cvt_pk_bf16_f32 v68, v120, v121
  v_cvt_pk_bf16_f32 v69, v122, v123
  v_cvt_pk_bf16_f32 v70, v124, v125
  v_cvt_pk_bf16_f32 v71, v126, v127
  s_add_u32 s43, s42, 13631488
  buffer_store_dwordx4 v[64:67], v8, s[8:11], s43 offen sc1
  buffer_store_dwordx4 v[68:71], v8, s[8:11], s43 offen offset:1024 sc1
  v_add_f32 v92, v96, v97
  v_add_f32 v94, v98, v99
  v_mul_f32 v93, v96, v96
  v_mul_f32 v95, v97, v97
  v_fmac_f32 v93, v98, v98
  v_fmac_f32 v95, v99, v99
  v_add_f32 v92, v92, v100
  v_add_f32 v94, v94, v101
  v_fmac_f32 v93, v100, v100
  v_fmac_f32 v95, v101, v101
  v_add_f32 v92, v92, v102
  v_add_f32 v94, v94, v103
  v_fmac_f32 v93, v102, v102
  v_fmac_f32 v95, v103, v103
  v_add_f32 v92, v92, v104
  v_add_f32 v94, v94, v105
  v_fmac_f32 v93, v104, v104
  v_fmac_f32 v95, v105, v105
  v_add_f32 v92, v92, v106
  v_add_f32 v94, v94, v107
  v_fmac_f32 v93, v106, v106
  v_fmac_f32 v95, v107, v107
  v_add_f32 v92, v92, v108
  v_add_f32 v94, v94, v109
  v_fmac_f32 v93, v108, v108
  v_fmac_f32 v95, v109, v109
  v_add_f32 v92, v92, v110
  v_add_f32 v94, v94, v111
  v_fmac_f32 v93, v110, v110
  v_fmac_f32 v95, v111, v111
  v_add_f32 v92, v92, v94
  v_add_f32 v93, v93, v95
  v_mov_b32 v94, v92
  v_mov_b32 v95, v93
  s_nop 0
  v_permlane32_swap_b32 v92, v94
  v_permlane32_swap_b32 v93, v95
  v_add_f32 v92, v92, v94
  v_add_f32 v93, v93, v95
  v_lshlrev_b32 v7, 7, v3
  s_lshl_b32 s44, s36, 12
  s_lshl_b32 s43, s35, 3
  s_add_u32 s44, s44, s43
  s_add_u32 s44, s44, 262144
  buffer_store_dwordx2 v[92:93], v7, s[8:11], s44 offen sc1
  s_lshl_b32 s43, s3, 11
  s_add_u32 s43, s43, 155648
  v_add_u32 v7, s43, v8
  ds_write_b128 v7, v[84:87]
  ds_write_b128 v7, v[88:91] offset:1024
  s_lshl_b32 s38, s36, 8
  s_add_u32 s38, s38, 212992
  s_waitcnt vmcnt(0)
  v_mov_b32 v0, 0
  v_mov_b32 v1, 1
  s_mov_b64 exec, 1
  buffer_atomic_add v1, v0, s[8:11], s38 offen sc1
  s_mov_b64 exec, -1
  s_bfe_u32 s33, s2, 0x10002
  s_lshl_b32 s33, s33, 3
  s_bfe_u32 s34, s2, 0x30003
  s_add_u32 s33, s33, s34
  s_and_b32 s34, s2, 3
  s_lshl_b32 s34, s34, 2
  s_lshr_b32 s35, s2, 6
  s_add_u32 s34, s34, s35
  s_cmp_ge_u32 s34, 15
  s_cbranch_scc1 UT_GO
  s_lshl_b32 s36, s33, 2
  s_add_u32 s36, s36, s50
  v_and_b32 v3, 31, v2
  v_lshrrev_b32 v4, 5, v2
  v_mov_b32 v9, v8
  v_add_u32 v11, 49152, v9
  v_lshlrev_b32 v5, 4, v4
  v_add_u32 v5, 147456, v5
  v_lshlrev_b32 v6, 7, v3
  v_lshl_add_u32 v6, v4, 6, v6
  s_lshl_b32 s41, s36, 12
  s_add_u32 s41, s41, 262144
  s_lshl_b32 s37, s36, 15
  s_add_u32 s37, s37, 22020096
  s_mul_i32 s44, s36, 88064
  s_mul_i32 s43, s34, 6144
  s_add_u32 s44, s44, s43
  s_add_u32 s44, s44, 13631488
  s_mov_b32 s45, 1069066811
  s_mov_b32 s46, 49152
  s_mov_b32 s47, 0
  s_mov_b32 s48, 4294918144
  s_lshl_b32 s38, s36, 8
  s_add_u32 s38, s38, 212992
  v_mov_b32 v160, 0
  v_mov_b32 v161, 0
  v_mov_b32 v162, 0
  v_mov_b32 v163, 0
  v_mov_b32 v164, 0
  v_mov_b32 v165, 0
  v_mov_b32 v166, 0
  v_mov_b32 v167, 0
  v_mov_b32 v168, 0
  v_mov_b32 v169, 0
  v_mov_b32 v170, 0
  v_mov_b32 v171, 0
  v_mov_b32 v172, 0
  v_mov_b32 v173, 0
  v_mov_b32 v174, 0
  v_mov_b32 v175, 0
  v_mov_b32 v176, 0
  v_mov_b32 v177, 0
  v_mov_b32 v178, 0
  v_mov_b32 v179, 0
  v_mov_b32 v180, 0
  v_mov_b32 v181, 0
  v_mov_b32 v182, 0
  v_mov_b32 v183, 0
  v_mov_b32 v184, 0
  v_mov_b32 v185, 0
  v_mov_b32 v186, 0
  v_mov_b32 v187, 0
  v_mov_b32 v188, 0
  v_mov_b32 v189, 0
  v_mov_b32 v190, 0
  v_mov_b32 v191, 0
  v_mov_b32 v192, 0
  v_mov_b32 v193, 0
  v_mov_b32 v194, 0
  v_mov_b32 v195, 0
  v_mov_b32 v196, 0
  v_mov_b32 v197, 0
  v_mov_b32 v198, 0
  v_mov_b32 v199, 0
  v_mov_b32 v200, 0
  v_mov_b32 v201, 0
  v_mov_b32 v202, 0
  v_mov_b32 v203, 0
  v_mov_b32 v204, 0
  v_mov_b32 v205, 0
  v_mov_b32 v206, 0
  v_mov_b32 v207, 0
  v_mov_b32 v208, 0
  v_mov_b32 v209, 0
  v_mov_b32 v210, 0
  v_mov_b32 v211, 0
  v_mov_b32 v212, 0
  v_mov_b32 v213, 0
  v_mov_b32 v214, 0
  v_mov_b32 v215, 0
  v_mov_b32 v216, 0
  v_mov_b32 v217, 0
  v_mov_b32 v218, 0
  v_mov_b32 v219, 0
  v_mov_b32 v220, 0
  v_mov_b32 v221, 0
  v_mov_b32 v222, 0
  v_mov_b32 v223, 0
  v_mov_b32 v224, 0
  v_mov_b32 v225, 0
  v_mov_b32 v226, 0
  v_mov_b32 v227, 0
  v_mov_b32 v228, 0
  v_mov_b32 v229, 0
  v_mov_b32 v230, 0
  v_mov_b32 v231, 0
  v_mov_b32 v232, 0
  v_mov_b32 v233, 0
  v_mov_b32 v234, 0
  v_mov_b32 v235, 0
  v_mov_b32 v236, 0
  v_mov_b32 v237, 0
  v_mov_b32 v238, 0
  v_mov_b32 v239, 0
  v_mov_b32 v240, 0
  v_mov_b32 v241, 0
  v_mov_b32 v242, 0
  v_mov_b32 v243, 0
  v_mov_b32 v244, 0
  v_mov_b32 v245, 0
  v_mov_b32 v246, 0
  v_mov_b32 v247, 0
  v_mov_b32 v248, 0
  v_mov_b32 v249, 0
  v_mov_b32 v250, 0
  v_mov_b32 v251, 0
  v_mov_b32 v252, 0
  v_mov_b32 v253, 0
  v_mov_b32 v254, 0
  v_mov_b32 v255, 0
  v_mov_b32 v0, 0
  s_mov_b32 s31, 0
C_PL3:
  buffer_load_dword v1, v0, s[8:11], s38 offen sc1
  s_waitcnt vmcnt(0)
  v_readfirstlane_b32 s30, v1
  s_add_u32 s31, s31, 1
  s_cmp_ge_u32 s30, 16
  s_cbranch_scc1 C_PL3_OK
  s_cmp_ge_u32 s31, 0x100000
  s_cbranch_scc1 C_PL3_OK
  s_sleep 1
  s_branch C_PL3
C_PL3_OK:
  buffer_load_dwordx4 v[144:147], v6, s[8:11], s41 offen offset:0 sc1
  buffer_load_dwordx4 v[148:151], v6, s[8:11], s41 offen offset:16 sc1
  buffer_load_dwordx4 v[152:155], v6, s[8:11], s41 offen offset:32 sc1
  buffer_load_dwordx4 v[156:159], v6, s[8:11], s41 offen offset:48 sc1
  buffer_load_dwordx4 v[112:115], v8, s[8:11], s37 offen offset:0 sc1
  buffer_load_dwordx4 v[116:119], v8, s[8:11], s37 offen offset:1024 sc1
  buffer_load_dwordx4 v[120:123], v8, s[8:11], s37 offen offset:2048 sc1
  buffer_load_dwordx4 v[124:127], v8, s[8:11], s37 offen offset:3072 sc1
  s_add_u32 s37, s37, 4096
  buffer_load_dwordx4 v[128:131], v8, s[8:11], s37 offen offset:0 sc1
  buffer_load_dwordx4 v[132:135], v8, s[8:11], s37 offen offset:1024 sc1
  buffer_load_dwordx4 v[136:139], v8, s[8:11], s37 offen offset:2048 sc1
  buffer_load_dwordx4 v[140:143], v8, s[8:11], s37 offen offset:3072 sc1
  s_add_u32 s37, s37, 4096
  s_barrier
  ds_read_b128 v[16:19], v9 offset:0
  ds_read_b128 v[20:23], v9 offset:1024
  ds_read_b128 v[24:27], v9 offset:2048
  ds_read_b128 v[28:31], v9 offset:3072
  ds_read_b128 v[32:35], v9 offset:4096
  ds_read_b128 v[36:39], v9 offset:5120
  ds_read_b128 v[40:43], v9 offset:6144
  ds_read_b128 v[44:47], v9 offset:7168
  ds_read_b128 v[48:51], v9 offset:8192
  ds_read_b128 v[52:55], v9 offset:9216
  ds_read_b128 v[56:59], v9 offset:10240
  ds_read_b128 v[60:63], v9 offset:11264
P3_LOOP:
  s_barrier
  ds_read_b128 v[64:67], v9 offset:12288
  ds_read_b128 v[68:71], v9 offset:13312
  ds_read_b128 v[72:75], v9 offset:14336
  s_waitcnt vmcnt(7) lgkmcnt(12)
  v_mfma_f32_32x32x16_bf16 v[160:175], v[16:19], v[112:115], v[160:175]
  v_mfma_f32_32x32x16_bf16 v[176:191], v[20:23], v[112:115], v[176:191]
  v_mfma_f32_32x32x16_bf16 v[192:207], v[24:27], v[112:115], v[192:207]
  ds_read_b128 v[76:79], v9 offset:15360
  ds_read_b128 v[80:83], v9 offset:16384
  ds_read_b128 v[84:87], v9 offset:17408
  s_waitcnt lgkmcnt(12)
  v_mfma_f32_32x32x16_bf16 v[208:223], v[28:31], v[112:115], v[208:223]
  v_mfma_f32_32x32x16_bf16 v[224:239], v[32:35], v[112:115], v[224:239]
  v_mfma_f32_32x32x16_bf16 v[240:255], v[36:39], v[112:115], v[240:255]
  buffer_load_dwordx4 v[112:115], v8, s[8:11], s37 offen offset:0 sc1
  ds_read_b128 v[88:91], v9 offset:18432
  ds_read_b128 v[92:95], v9 offset:19456
  ds_read_b128 v[96:99], v9 offset:20480
  s_waitcnt vmcnt(7) lgkmcnt(12)
  v_mfma_f32_32x32x16_bf16 v[160:175], v[40:43], v[116:119], v[160:175]
  v_mfma_f32_32x32x16_bf16 v[176:191], v[44:47], v[116:119], v[176:191]
  v_mfma_f32_32x32x16_bf16 v[192:207], v[48:51], v[116:119], v[192:207]
  ds_read_b128 v[100:103], v9 offset:21504
  ds_read_b128 v[104:107], v9 offset:22528
  ds_read_b128 v[108:111], v9 offset:23552
  s_waitcnt lgkmcnt(12)
  v_mfma_f32_32x32x16_bf16 v[208:223], v[52:55], v[116:119], v[208:223]
  v_mfma_f32_32x32x16_bf16 v[224:239], v[56:59], v[116:119], v[224:239]
  v_mfma_f32_32x32x16_bf16 v[240:255], v[60:63], v[116:119], v[240:255]
  buffer_load_dwordx4 v[116:119], v8, s[8:11], s37 offen offset:1024 sc1
  s_barrier
  ds_read_b128 v[16:19], v9 offset:24576
  ds_read_b128 v[20:23], v9 offset:25600
  ds_read_b128 v[24:27], v9 offset:26624
  s_waitcnt vmcnt(7) lgkmcnt(12)
  v_mfma_f32_32x32x16_bf16 v[160:175], v[64:67], v[120:123], v[160:175]
  v_mfma_f32_32x32x16_bf16 v[176:191], v[68:71], v[120:123], v[176:191]
  v_mfma_f32_32x32x16_bf16 v[192:207], v[72:75], v[120:123], v[192:207]
  ds_read_b128 v[28:31], v9 offset:27648
  ds_read_b128 v[32:35], v9 offset:28672
  ds_read_b128 v[36:39], v9 offset:29696
  s_waitcnt lgkmcnt(12)
  v_mfma_f32_32x32x16_bf16 v[208:223], v[76:79], v[120:123], v[208:223]
  v_mfma_f32_32x32x16_bf16 v[224:239], v[80:83], v[120:123], v[224:239]
  v_mfma_f32_32x32x16_bf16 v[240:255], v[84:87], v[120:123], v[240:255]
  buffer_load_dwordx4 v[120:123], v8, s[8:11], s37 offen offset:2048 sc1
  ds_read_b128 v[40:43], v9 offset:30720
  ds_read_b128 v[44:47], v9 offset:31744
  ds_read_b128 v[48:51], v9 offset:32768
  s_waitcnt vmcnt(7) lgkmcnt(12)
  v_mfma_f32_32x32x16_bf16 v[160:175], v[88:91], v[124:127], v[160:175]
  v_mfma_f32_32x32x16_bf16 v[176:191], v[92:95], v[124:127], v[176:191]
  v_mfma_f32_32x32x16_bf16 v[192:207], v[96:99], v[124:127], v[192:207]
  ds_read_b128 v[52:55], v9 offset:33792
  ds_read_b128 v[56:59], v9 offset:34816
  ds_read_b128 v[60:63], v9 offset:35840
  s_waitcnt lgkmcnt(12)
  v_mfma_f32_32x32x16_bf16 v[208:223], v[100:103], v[124:127], v[208:223]
  v_mfma_f32_32x32x16_bf16 v[224:239], v[104:107], v[124:127], v[224:239]
  v_mfma_f32_32x32x16_bf16 v[240:255], v[108:111], v[124:127], v[240:255]
  buffer_load_dwordx4 v[124:127], v8, s[8:11], s37 offen offset:3072 sc1
  s_add_u32 s37, s37, 4096
  s_barrier
  ds_read_b128 v[64:67], v9 offset:36864
  ds_read_b128 v[68:71], v9 offset:37888
  ds_read_b128 v[72:75], v9 offset:38912
  s_waitcnt vmcnt(7) lgkmcnt(12)
  v_mfma_f32_32x32x16_bf16 v[160:175], v[16:19], v[128:131], v[160:175]
  v_mfma_f32_32x32x16_bf16 v[176:191], v[20:23], v[128:131], v[176:191]
  v_mfma_f32_32x32x16_bf16 v[192:207], v[24:27], v[128:131], v[192:207]
  ds_read_b128 v[76:79], v9 offset:39936
  ds_read_b128 v[80:83], v9 offset:40960
  ds_read_b128 v[84:87], v9 offset:41984
  s_waitcnt lgkmcnt(12)
  v_mfma_f32_32x32x16_bf16 v[208:223], v[28:31], v[128:131], v[208:223]
  v_mfma_f32_32x32x16_bf16 v[224:239], v[32:35], v[128:131], v[224:239]
  v_mfma_f32_32x32x16_bf16 v[240:255], v[36:39], v[128:131], v[240:255]
  buffer_load_dwordx4 v[128:131], v8, s[8:11], s37 offen offset:0 sc1
  ds_read_b128 v[88:91], v9 offset:43008
  ds_read_b128 v[92:95], v9 offset:44032
  ds_read_b128 v[96:99], v9 offset:45056
  s_waitcnt vmcnt(7) lgkmcnt(12)
  v_mfma_f32_32x32x16_bf16 v[160:175], v[40:43], v[132:135], v[160:175]
  v_mfma_f32_32x32x16_bf16 v[176:191], v[44:47], v[132:135], v[176:191]
  v_mfma_f32_32x32x16_bf16 v[192:207], v[48:51], v[132:135], v[192:207]
  ds_read_b128 v[100:103], v9 offset:46080
  ds_read_b128 v[104:107], v9 offset:47104
  ds_read_b128 v[108:111], v9 offset:48128
  s_waitcnt lgkmcnt(12)
  v_mfma_f32_32x32x16_bf16 v[208:223], v[52:55], v[132:135], v[208:223]
  v_mfma_f32_32x32x16_bf16 v[224:239], v[56:59], v[132:135], v[224:239]
  v_mfma_f32_32x32x16_bf16 v[240:255], v[60:63], v[132:135], v[240:255]
  buffer_load_dwordx4 v[132:135], v8, s[8:11], s37 offen offset:1024 sc1
  s_barrier
  ds_read_b128 v[16:19], v11 offset:0
  ds_read_b128 v[20:23], v11 offset:1024
  ds_read_b128 v[24:27], v11 offset:2048
  s_waitcnt vmcnt(7) lgkmcnt(12)
  v_mfma_f32_32x32x16_bf16 v[160:175], v[64:67], v[136:139], v[160:175]
  v_mfma_f32_32x32x16_bf16 v[176:191], v[68:71], v[136:139], v[176:191]
  v_mfma_f32_32x32x16_bf16 v[192:207], v[72:75], v[136:139], v[192:207]
  ds_read_b128 v[28:31], v11 offset:3072
  ds_read_b128 v[32:35], v11 offset:4096
  ds_read_b128 v[36:39], v11 offset:5120
  s_waitcnt lgkmcnt(12)
  v_mfma_f32_32x32x16_bf16 v[208:223], v[76:79], v[136:139], v[208:223]
  v_mfma_f32_32x32x16_bf16 v[224:239], v[80:83], v[136:139], v[224:239]
  v_mfma_f32_32x32x16_bf16 v[240:255], v[84:87], v[136:139], v[240:255]
  buffer_load_dwordx4 v[136:139], v8, s[8:11], s37 offen offset:2048 sc1
  ds_read_b128 v[40:43], v11 offset:6144
  ds_read_b128 v[44:47], v11 offset:7168
  ds_read_b128 v[48:51], v11 offset:8192
  s_waitcnt vmcnt(7) lgkmcnt(12)
  v_mfma_f32_32x32x16_bf16 v[160:175], v[88:91], v[140:143], v[160:175]
  v_mfma_f32_32x32x16_bf16 v[176:191], v[92:95], v[140:143], v[176:191]
  v_mfma_f32_32x32x16_bf16 v[192:207], v[96:99], v[140:143], v[192:207]
  ds_read_b128 v[52:55], v11 offset:9216
  ds_read_b128 v[56:59], v11 offset:10240
  ds_read_b128 v[60:63], v11 offset:11264
  s_waitcnt lgkmcnt(12)
  v_mfma_f32_32x32x16_bf16 v[208:223], v[100:103], v[140:143], v[208:223]
  v_mfma_f32_32x32x16_bf16 v[224:239], v[104:107], v[140:143], v[224:239]
  v_mfma_f32_32x32x16_bf16 v[240:255], v[108:111], v[140:143], v[240:255]
  buffer_load_dwordx4 v[140:143], v8, s[8:11], s37 offen offset:3072 sc1
  s_add_u32 s37, s37, 4096
  v_mov_b32 v9, v11
  s_add_u32 s46, s46, 49152
  s_cmp_eq_u32 s46, 147456
  s_cselect_b32 s49, 98304, s48
  s_cselect_b32 s46, 0, s46
  v_subrev_u32 v11, s49, v11
  s_add_u32 s47, s47, 1
  s_cmp_eq_u32 s47, 3
  s_cselect_b32 s37, 0x7ff00000, s37
  s_cmp_lt_u32 s47, 4
  s_cbranch_scc1 P3_LOOP
  s_waitcnt vmcnt(0) lgkmcnt(0)
  s_barrier
  ds_read_b128 v[16:19], v5 offset:0
  ds_read_b128 v[20:23], v5 offset:32
  ds_read_b128 v[24:27], v5 offset:64
  ds_read_b128 v[28:31], v5 offset:96
  ds_read_b128 v[32:35], v5 offset:384
  ds_read_b128 v[36:39], v5 offset:416
  ds_read_b128 v[40:43], v5 offset:448
  ds_read_b128 v[44:47], v5 offset:480
  ds_read_b128 v[48:51], v5 offset:768
  ds_read_b128 v[52:55], v5 offset:800
  ds_read_b128 v[56:59], v5 offset:832
  ds_read_b128 v[60:63], v5 offset:864
  ds_read_b128 v[64:67], v5 offset:1152
  ds_read_b128 v[68:71], v5 offset:1184
  ds_read_b128 v[72:75], v5 offset:1216
  ds_read_b128 v[76:79], v5 offset:1248
  v_add_f32 v144, v144, v146
  v_add_f32 v145, v145, v147
  v_add_f32 v144, v144, v148
  v_add_f32 v145, v145, v149
  v_add_f32 v144, v144, v150
  v_add_f32 v145, v145, v151
  v_add_f32 v144, v144, v152
  v_add_f32 v145, v145, v153
  v_add_f32 v144, v144, v154
  v_add_f32 v145, v145, v155
  v_add_f32 v144, v144, v156
  v_add_f32 v145, v145, v157
  v_add_f32 v144, v144, v158
  v_add_f32 v145, v145, v159
  v_mov_b32 v146, v144
  v_mov_b32 v147, v145
  s_nop 0
  v_permlane32_swap_b32 v144, v146
  v_permlane32_swap_b32 v145, v147
  v_add_f32 v144, v144, v146
  v_add_f32 v145, v145, v147
  v_mul_f32 v13, 0x3b000000, v144
  v_mul_f32 v12, 0x3b000000, v145
  v_fma_f32 v12, -v13, v13, v12
  v_max_f32 v12, 0, v12
  v_add_f32 v12, 0x3727c5ac, v12
  v_rsq_f32 v14, v12
  v_sub_f32 v15, 0, v13
  s_waitcnt lgkmcnt(8)
  v_fmac_f32 v160, v16, v15
  v_fmac_f32 v161, v17, v15
  v_fmac_f32 v162, v18, v15
  v_fmac_f32 v163, v19, v15
  v_fmac_f32 v164, v20, v15
  v_fmac_f32 v165, v21, v15
  v_fmac_f32 v166, v22, v15
  v_fmac_f32 v167, v23, v15
  v_fmac_f32 v168, v24, v15
  v_fmac_f32 v169, v25, v15
  v_fmac_f32 v170, v26, v15
  v_fmac_f32 v171, v27, v15
  v_fmac_f32 v172, v28, v15
  v_fmac_f32 v173, v29, v15
  v_fmac_f32 v174, v30, v15
  v_fmac_f32 v175, v31, v15
  v_fma_f32 v160, v160, v14, v32
  v_fma_f32 v161, v161, v14, v33
  v_fma_f32 v162, v162, v14, v34
  v_fma_f32 v163, v163, v14, v35
  v_fma_f32 v164, v164, v14, v36
  v_fma_f32 v165, v165, v14, v37
  v_fma_f32 v166, v166, v14, v38
  v_fma_f32 v167, v167, v14, v39
  v_fma_f32 v168, v168, v14, v40
  v_fma_f32 v169, v169, v14, v41
  v_fma_f32 v170, v170, v14, v42
  v_fma_f32 v171, v171, v14, v43
  v_fma_f32 v172, v172, v14, v44
  v_fma_f32 v173, v173, v14, v45
  v_fma_f32 v174, v174, v14, v46
  v_fma_f32 v175, v175, v14, v47
  s_waitcnt lgkmcnt(0)
  v_fmac_f32 v176, v48, v15
  v_fmac_f32 v177, v49, v15
  v_fmac_f32 v178, v50, v15
  v_fmac_f32 v179, v51, v15
  v_fmac_f32 v180, v52, v15
  v_fmac_f32 v181, v53, v15
  v_fmac_f32 v182, v54, v15
  v_fmac_f32 v183, v55, v15
  v_fmac_f32 v184, v56, v15
  v_fmac_f32 v185, v57, v15
  v_fmac_f32 v186, v58, v15
  v_fmac_f32 v187, v59, v15
  v_fmac_f32 v188, v60, v15
  v_fmac_f32 v189, v61, v15
  v_fmac_f32 v190, v62, v15
  v_fmac_f32 v191, v63, v15
  v_fma_f32 v176, v176, v14, v64
  v_fma_f32 v177, v177, v14, v65
  v_fma_f32 v178, v178, v14, v66
  v_fma_f32 v179, v179, v14, v67
  v_fma_f32 v180, v180, v14, v68
  v_fma_f32 v181, v181, v14, v69
  v_fma_f32 v182, v182, v14, v70
  v_fma_f32 v183, v183, v14, v71
  v_fma_f32 v184, v184, v14, v72
  v_fma_f32 v185, v185, v14, v73
  v_fma_f32 v186, v186, v14, v74
  v_fma_f32 v187, v187, v14, v75
  v_fma_f32 v188, v188, v14, v76
  v_fma_f32 v189, v189, v14, v77
  v_fma_f32 v190, v190, v14, v78
  v_fma_f32 v191, v191, v14, v79
  ds_read_b128 v[16:19], v5 offset:128
  ds_read_b128 v[20:23], v5 offset:160
  ds_read_b128 v[24:27], v5 offset:192
  ds_read_b128 v[28:31], v5 offset:224
  ds_read_b128 v[32:35], v5 offset:512
  ds_read_b128 v[36:39], v5 offset:544
  ds_read_b128 v[40:43], v5 offset:576
  ds_read_b128 v[44:47], v5 offset:608
  ds_read_b128 v[48:51], v5 offset:896
  ds_read_b128 v[52:55], v5 offset:928
  ds_read_b128 v[56:59], v5 offset:960
  ds_read_b128 v[60:63], v5 offset:992
  ds_read_b128 v[64:67], v5 offset:1280
  ds_read_b128 v[68:71], v5 offset:1312
  ds_read_b128 v[72:75], v5 offset:1344
  ds_read_b128 v[76:79], v5 offset:1376
  v_mul_f32 v80, s45, v160
  v_mul_f32 v81, s45, v161
  v_mul_f32 v82, s45, v162
  v_mul_f32 v83, s45, v163
  v_mul_f32 v84, s45, v164
  v_mul_f32 v85, s45, v165
  v_mul_f32 v86, s45, v166
  v_mul_f32 v87, s45, v167
  v_mul_f32 v88, s45, v168
  v_mul_f32 v89, s45, v169
  v_mul_f32 v90, s45, v170
  v_mul_f32 v91, s45, v171
  v_mul_f32 v92, s45, v172
  v_mul_f32 v93, s45, v173
  v_mul_f32 v94, s45, v174
  v_mul_f32 v95, s45, v175
  v_exp_f32 v80, -v80
  v_exp_f32 v81, -v81
  v_exp_f32 v82, -v82
  v_exp_f32 v83, -v83
  v_exp_f32 v84, -v84
  v_exp_f32 v85, -v85
  v_exp_f32 v86, -v86
  v_exp_f32 v87, -v87
  v_exp_f32 v88, -v88
  v_exp_f32 v89, -v89
  v_exp_f32 v90, -v90
  v_exp_f32 v91, -v91
  v_exp_f32 v92, -v92
  v_exp_f32 v93, -v93
  v_exp_f32 v94, -v94
  v_exp_f32 v95, -v95
  v_mul_f32 v160, v160, v176
  v_mul_f32 v161, v161, v177
  v_mul_f32 v162, v162, v178
  v_mul_f32 v163, v163, v179
  v_mul_f32 v164, v164, v180
  v_mul_f32 v165, v165, v181
  v_mul_f32 v166, v166, v182
  v_mul_f32 v167, v167, v183
  v_mul_f32 v168, v168, v184
  v_mul_f32 v169, v169, v185
  v_mul_f32 v170, v170, v186
  v_mul_f32 v171, v171, v187
  v_mul_f32 v172, v172, v188
  v_mul_f32 v173, v173, v189
  v_mul_f32 v174, v174, v190
  v_mul_f32 v175, v175, v191
  v_add_f32 v80, 1.0, v80
  v_add_f32 v81, 1.0, v81
  v_add_f32 v82, 1.0, v82
  v_add_f32 v83, 1.0, v83
  v_add_f32 v84, 1.0, v84
  v_add_f32 v85, 1.0, v85
  v_add_f32 v86, 1.0, v86
  v_add_f32 v87, 1.0, v87
  v_add_f32 v88, 1.0, v88
  v_add_f32 v89, 1.0, v89
  v_add_f32 v90, 1.0, v90
  v_add_f32 v91, 1.0, v91
  v_add_f32 v92, 1.0, v92
  v_add_f32 v93, 1.0, v93
  v_add_f32 v94, 1.0, v94
  v_add_f32 v95, 1.0, v95
  v_rcp_f32 v80, v80
  v_rcp_f32 v81, v81
  v_rcp_f32 v82, v82
  v_rcp_f32 v83, v83
  v_rcp_f32 v84, v84
  v_rcp_f32 v85, v85
  v_rcp_f32 v86, v86
  v_rcp_f32 v87, v87
  v_rcp_f32 v88, v88
  v_rcp_f32 v89, v89
  v_rcp_f32 v90, v90
  v_rcp_f32 v91, v91
  v_rcp_f32 v92, v92
  v_rcp_f32 v93, v93
  v_rcp_f32 v94, v94
  v_rcp_f32 v95, v95
  v_mul_f32 v160, v160, v80
  v_mul_f32 v161, v161, v81
  v_mul_f32 v162, v162, v82
  v_mul_f32 v163, v163, v83
  v_mul_f32 v164, v164, v84
  v_mul_f32 v165, v165, v85
  v_mul_f32 v166, v166, v86
  v_mul_f32 v167, v167, v87
  v_mul_f32 v168, v168, v88
  v_mul_f32 v169, v169, v89
  v_mul_f32 v170, v170, v90
  v_mul_f32 v171, v171, v91
  v_mul_f32 v172, v172, v92
  v_mul_f32 v173, v173, v93
  v_mul_f32 v174, v174, v94
  v_mul_f32 v175, v175, v95
  v_cvt_pk_bf16_f32 v96, v160, v161
  v_cvt_pk_bf16_f32 v97, v162, v163
  v_cvt_pk_bf16_f32 v98, v164, v165
  v_cvt_pk_bf16_f32 v99, v166, v167
  v_cvt_pk_bf16_f32 v100, v168, v169
  v_cvt_pk_bf16_f32 v101, v170, v171
  v_cvt_pk_bf16_f32 v102, v172, v173
  v_cvt_pk_bf16_f32 v103, v174, v175
  buffer_store_dwordx4 v[96:99], v8, s[8:11], s44 offen offset:0 sc1
  buffer_store_dwordx4 v[100:103], v8, s[8:11], s44 offen offset:1024 sc1
  s_cmp_eq_u32 s34, 14
  s_cbranch_scc1 P3_FIN
  s_waitcnt lgkmcnt(8)
  v_fmac_f32 v192, v16, v15
  v_fmac_f32 v193, v17, v15
  v_fmac_f32 v194, v18, v15
  v_fmac_f32 v195, v19, v15
  v_fmac_f32 v196, v20, v15
  v_fmac_f32 v197, v21, v15
  v_fmac_f32 v198, v22, v15
  v_fmac_f32 v199, v23, v15
  v_fmac_f32 v200, v24, v15
  v_fmac_f32 v201, v25, v15
  v_fmac_f32 v202, v26, v15
  v_fmac_f32 v203, v27, v15
  v_fmac_f32 v204, v28, v15
  v_fmac_f32 v205, v29, v15
  v_fmac_f32 v206, v30, v15
  v_fmac_f32 v207, v31, v15
  v_fma_f32 v192, v192, v14, v32
  v_fma_f32 v193, v193, v14, v33
  v_fma_f32 v194, v194, v14, v34
  v_fma_f32 v195, v195, v14, v35
  v_fma_f32 v196, v196, v14, v36
  v_fma_f32 v197, v197, v14, v37
  v_fma_f32 v198, v198, v14, v38
  v_fma_f32 v199, v199, v14, v39
  v_fma_f32 v200, v200, v14, v40
  v_fma_f32 v201, v201, v14, v41
  v_fma_f32 v202, v202, v14, v42
  v_fma_f32 v203, v203, v14, v43
  v_fma_f32 v204, v204, v14, v44
  v_fma_f32 v205, v205, v14, v45
  v_fma_f32 v206, v206, v14, v46
  v_fma_f32 v207, v207, v14, v47
  s_waitcnt lgkmcnt(0)
  v_fmac_f32 v208, v48, v15
  v_fmac_f32 v209, v49, v15
  v_fmac_f32 v210, v50, v15
  v_fmac_f32 v211, v51, v15
  v_fmac_f32 v212, v52, v15
  v_fmac_f32 v213, v53, v15
  v_fmac_f32 v214, v54, v15
  v_fmac_f32 v215, v55, v15
  v_fmac_f32 v216, v56, v15
  v_fmac_f32 v217, v57, v15
  v_fmac_f32 v218, v58, v15
  v_fmac_f32 v219, v59, v15
  v_fmac_f32 v220, v60, v15
  v_fmac_f32 v221, v61, v15
  v_fmac_f32 v222, v62, v15
  v_fmac_f32 v223, v63, v15
  v_fma_f32 v208, v208, v14, v64
  v_fma_f32 v209, v209, v14, v65
  v_fma_f32 v210, v210, v14, v66
  v_fma_f32 v211, v211, v14, v67
  v_fma_f32 v212, v212, v14, v68
  v_fma_f32 v213, v213, v14, v69
  v_fma_f32 v214, v214, v14, v70
  v_fma_f32 v215, v215, v14, v71
  v_fma_f32 v216, v216, v14, v72
  v_fma_f32 v217, v217, v14, v73
  v_fma_f32 v218, v218, v14, v74
  v_fma_f32 v219, v219, v14, v75
  v_fma_f32 v220, v220, v14, v76
  v_fma_f32 v221, v221, v14, v77
  v_fma_f32 v222, v222, v14, v78
  v_fma_f32 v223, v223, v14, v79
  ds_read_b128 v[16:19], v5 offset:256
  ds_read_b128 v[20:23], v5 offset:288
  ds_read_b128 v[24:27], v5 offset:320
  ds_read_b128 v[28:31], v5 offset:352
  ds_read_b128 v[32:35], v5 offset:640
  ds_read_b128 v[36:39], v5 offset:672
  ds_read_b128 v[40:43], v5 offset:704
  ds_read_b128 v[44:47], v5 offset:736
  ds_read_b128 v[48:51], v5 offset:1024
  ds_read_b128 v[52:55], v5 offset:1056
  ds_read_b128 v[56:59], v5 offset:1088
  ds_read_b128 v[60:63], v5 offset:1120
  ds_read_b128 v[64:67], v5 offset:1408
  ds_read_b128 v[68:71], v5 offset:1440
  ds_read_b128 v[72:75], v5 offset:1472
  ds_read_b128 v[76:79], v5 offset:1504
  v_mul_f32 v80, s45, v192
  v_mul_f32 v81, s45, v193
  v_mul_f32 v82, s45, v194
  v_mul_f32 v83, s45, v195
  v_mul_f32 v84, s45, v196
  v_mul_f32 v85, s45, v197
  v_mul_f32 v86, s45, v198
  v_mul_f32 v87, s45, v199
  v_mul_f32 v88, s45, v200
  v_mul_f32 v89, s45, v201
  v_mul_f32 v90, s45, v202
  v_mul_f32 v91, s45, v203
  v_mul_f32 v92, s45, v204
  v_mul_f32 v93, s45, v205
  v_mul_f32 v94, s45, v206
  v_mul_f32 v95, s45, v207
  v_exp_f32 v80, -v80
  v_exp_f32 v81, -v81
  v_exp_f32 v82, -v82
  v_exp_f32 v83, -v83
  v_exp_f32 v84, -v84
  v_exp_f32 v85, -v85
  v_exp_f32 v86, -v86
  v_exp_f32 v87, -v87
  v_exp_f32 v88, -v88
  v_exp_f32 v89, -v89
  v_exp_f32 v90, -v90
  v_exp_f32 v91, -v91
  v_exp_f32 v92, -v92
  v_exp_f32 v93, -v93
  v_exp_f32 v94, -v94
  v_exp_f32 v95, -v95
  v_mul_f32 v192, v192, v208
  v_mul_f32 v193, v193, v209
  v_mul_f32 v194, v194, v210
  v_mul_f32 v195, v195, v211
  v_mul_f32 v196, v196, v212
  v_mul_f32 v197, v197, v213
  v_mul_f32 v198, v198, v214
  v_mul_f32 v199, v199, v215
  v_mul_f32 v200, v200, v216
  v_mul_f32 v201, v201, v217
  v_mul_f32 v202, v202, v218
  v_mul_f32 v203, v203, v219
  v_mul_f32 v204, v204, v220
  v_mul_f32 v205, v205, v221
  v_mul_f32 v206, v206, v222
  v_mul_f32 v207, v207, v223
  v_add_f32 v80, 1.0, v80
  v_add_f32 v81, 1.0, v81
  v_add_f32 v82, 1.0, v82
  v_add_f32 v83, 1.0, v83
  v_add_f32 v84, 1.0, v84
  v_add_f32 v85, 1.0, v85
  v_add_f32 v86, 1.0, v86
  v_add_f32 v87, 1.0, v87
  v_add_f32 v88, 1.0, v88
  v_add_f32 v89, 1.0, v89
  v_add_f32 v90, 1.0, v90
  v_add_f32 v91, 1.0, v91
  v_add_f32 v92, 1.0, v92
  v_add_f32 v93, 1.0, v93
  v_add_f32 v94, 1.0, v94
  v_add_f32 v95, 1.0, v95
  v_rcp_f32 v80, v80
  v_rcp_f32 v81, v81
  v_rcp_f32 v82, v82
  v_rcp_f32 v83, v83
  v_rcp_f32 v84, v84
  v_rcp_f32 v85, v85
  v_rcp_f32 v86, v86
  v_rcp_f32 v87, v87
  v_rcp_f32 v88, v88
  v_rcp_f32 v89, v89
  v_rcp_f32 v90, v90
  v_rcp_f32 v91, v91
  v_rcp_f32 v92, v92
  v_rcp_f32 v93, v93
  v_rcp_f32 v94, v94
  v_rcp_f32 v95, v95
  v_mul_f32 v192, v192, v80
  v_mul_f32 v193, v193, v81
  v_mul_f32 v194, v194, v82
  v_mul_f32 v195, v195, v83
  v_mul_f32 v196, v196, v84
  v_mul_f32 v197, v197, v85
  v_mul_f32 v198, v198, v86
  v_mul_f32 v199, v199, v87
  v_mul_f32 v200, v200, v88
  v_mul_f32 v201, v201, v89
  v_mul_f32 v202, v202, v90
  v_mul_f32 v203, v203, v91
  v_mul_f32 v204, v204, v92
  v_mul_f32 v205, v205, v93
  v_mul_f32 v206, v206, v94
  v_mul_f32 v207, v207, v95
  v_cvt_pk_bf16_f32 v104, v192, v193
  v_cvt_pk_bf16_f32 v105, v194, v195
  v_cvt_pk_bf16_f32 v106, v196, v197
  v_cvt_pk_bf16_f32 v107, v198, v199
  v_cvt_pk_bf16_f32 v108, v200, v201
  v_cvt_pk_bf16_f32 v109, v202, v203
  v_cvt_pk_bf16_f32 v110, v204, v205
  v_cvt_pk_bf16_f32 v111, v206, v207
  buffer_store_dwordx4 v[104:107], v8, s[8:11], s44 offen offset:2048 sc1
  buffer_store_dwordx4 v[108:111], v8, s[8:11], s44 offen offset:3072 sc1
  s_add_u32 s44, s44, 4096
  s_waitcnt lgkmcnt(8)
  v_fmac_f32 v224, v16, v15
  v_fmac_f32 v225, v17, v15
  v_fmac_f32 v226, v18, v15
  v_fmac_f32 v227, v19, v15
  v_fmac_f32 v228, v20, v15
  v_fmac_f32 v229, v21, v15
  v_fmac_f32 v230, v22, v15
  v_fmac_f32 v231, v23, v15
  v_fmac_f32 v232, v24, v15
  v_fmac_f32 v233, v25, v15
  v_fmac_f32 v234, v26, v15
  v_fmac_f32 v235, v27, v15
  v_fmac_f32 v236, v28, v15
  v_fmac_f32 v237, v29, v15
  v_fmac_f32 v238, v30, v15
  v_fmac_f32 v239, v31, v15
  v_fma_f32 v224, v224, v14, v32
  v_fma_f32 v225, v225, v14, v33
  v_fma_f32 v226, v226, v14, v34
  v_fma_f32 v227, v227, v14, v35
  v_fma_f32 v228, v228, v14, v36
  v_fma_f32 v229, v229, v14, v37
  v_fma_f32 v230, v230, v14, v38
  v_fma_f32 v231, v231, v14, v39
  v_fma_f32 v232, v232, v14, v40
  v_fma_f32 v233, v233, v14, v41
  v_fma_f32 v234, v234, v14, v42
  v_fma_f32 v235, v235, v14, v43
  v_fma_f32 v236, v236, v14, v44
  v_fma_f32 v237, v237, v14, v45
  v_fma_f32 v238, v238, v14, v46
  v_fma_f32 v239, v239, v14, v47
  s_waitcnt lgkmcnt(0)
  v_fmac_f32 v240, v48, v15
  v_fmac_f32 v241, v49, v15
  v_fmac_f32 v242, v50, v15
  v_fmac_f32 v243, v51, v15
  v_fmac_f32 v244, v52, v15
  v_fmac_f32 v245, v53, v15
  v_fmac_f32 v246, v54, v15
  v_fmac_f32 v247, v55, v15
  v_fmac_f32 v248, v56, v15
  v_fmac_f32 v249, v57, v15
  v_fmac_f32 v250, v58, v15
  v_fmac_f32 v251, v59, v15
  v_fmac_f32 v252, v60, v15
  v_fmac_f32 v253, v61, v15
  v_fmac_f32 v254, v62, v15
  v_fmac_f32 v255, v63, v15
  v_fma_f32 v240, v240, v14, v64
  v_fma_f32 v241, v241, v14, v65
  v_fma_f32 v242, v242, v14, v66
  v_fma_f32 v243, v243, v14, v67
  v_fma_f32 v244, v244, v14, v68
  v_fma_f32 v245, v245, v14, v69
  v_fma_f32 v246, v246, v14, v70
  v_fma_f32 v247, v247, v14, v71
  v_fma_f32 v248, v248, v14, v72
  v_fma_f32 v249, v249, v14, v73
  v_fma_f32 v250, v250, v14, v74
  v_fma_f32 v251, v251, v14, v75
  v_fma_f32 v252, v252, v14, v76
  v_fma_f32 v253, v253, v14, v77
  v_fma_f32 v254, v254, v14, v78
  v_fma_f32 v255, v255, v14, v79
  v_mul_f32 v80, s45, v224
  v_mul_f32 v81, s45, v225
  v_mul_f32 v82, s45, v226
  v_mul_f32 v83, s45, v227
  v_mul_f32 v84, s45, v228
  v_mul_f32 v85, s45, v229
  v_mul_f32 v86, s45, v230
  v_mul_f32 v87, s45, v231
  v_mul_f32 v88, s45, v232
  v_mul_f32 v89, s45, v233
  v_mul_f32 v90, s45, v234
  v_mul_f32 v91, s45, v235
  v_mul_f32 v92, s45, v236
  v_mul_f32 v93, s45, v237
  v_mul_f32 v94, s45, v238
  v_mul_f32 v95, s45, v239
  v_exp_f32 v80, -v80
  v_exp_f32 v81, -v81
  v_exp_f32 v82, -v82
  v_exp_f32 v83, -v83
  v_exp_f32 v84, -v84
  v_exp_f32 v85, -v85
  v_exp_f32 v86, -v86
  v_exp_f32 v87, -v87
  v_exp_f32 v88, -v88
  v_exp_f32 v89, -v89
  v_exp_f32 v90, -v90
  v_exp_f32 v91, -v91
  v_exp_f32 v92, -v92
  v_exp_f32 v93, -v93
  v_exp_f32 v94, -v94
  v_exp_f32 v95, -v95
  v_mul_f32 v224, v224, v240
  v_mul_f32 v225, v225, v241
  v_mul_f32 v226, v226, v242
  v_mul_f32 v227, v227, v243
  v_mul_f32 v228, v228, v244
  v_mul_f32 v229, v229, v245
  v_mul_f32 v230, v230, v246
  v_mul_f32 v231, v231, v247
  v_mul_f32 v232, v232, v248
  v_mul_f32 v233, v233, v249
  v_mul_f32 v234, v234, v250
  v_mul_f32 v235, v235, v251
  v_mul_f32 v236, v236, v252
  v_mul_f32 v237, v237, v253
  v_mul_f32 v238, v238, v254
  v_mul_f32 v239, v239, v255
  v_add_f32 v80, 1.0, v80
  v_add_f32 v81, 1.0, v81
  v_add_f32 v82, 1.0, v82
  v_add_f32 v83, 1.0, v83
  v_add_f32 v84, 1.0, v84
  v_add_f32 v85, 1.0, v85
  v_add_f32 v86, 1.0, v86
  v_add_f32 v87, 1.0, v87
  v_add_f32 v88, 1.0, v88
  v_add_f32 v89, 1.0, v89
  v_add_f32 v90, 1.0, v90
  v_add_f32 v91, 1.0, v91
  v_add_f32 v92, 1.0, v92
  v_add_f32 v93, 1.0, v93
  v_add_f32 v94, 1.0, v94
  v_add_f32 v95, 1.0, v95
  v_rcp_f32 v80, v80
  v_rcp_f32 v81, v81
  v_rcp_f32 v82, v82
  v_rcp_f32 v83, v83
  v_rcp_f32 v84, v84
  v_rcp_f32 v85, v85
  v_rcp_f32 v86, v86
  v_rcp_f32 v87, v87
  v_rcp_f32 v88, v88
  v_rcp_f32 v89, v89
  v_rcp_f32 v90, v90
  v_rcp_f32 v91, v91
  v_rcp_f32 v92, v92
  v_rcp_f32 v93, v93
  v_rcp_f32 v94, v94
  v_rcp_f32 v95, v95
  v_mul_f32 v224, v224, v80
  v_mul_f32 v225, v225, v81
  v_mul_f32 v226, v226, v82
  v_mul_f32 v227, v227, v83
  v_mul_f32 v228, v228, v84
  v_mul_f32 v229, v229, v85
  v_mul_f32 v230, v230, v86
  v_mul_f32 v231, v231, v87
  v_mul_f32 v232, v232, v88
  v_mul_f32 v233, v233, v89
  v_mul_f32 v234, v234, v90
  v_mul_f32 v235, v235, v91
  v_mul_f32 v236, v236, v92
  v_mul_f32 v237, v237, v93
  v_mul_f32 v238, v238, v94
  v_mul_f32 v239, v239, v95
  v_cvt_pk_bf16_f32 v112, v224, v225
  v_cvt_pk_bf16_f32 v113, v226, v227
  v_cvt_pk_bf16_f32 v114, v228, v229
  v_cvt_pk_bf16_f32 v115, v230, v231
  v_cvt_pk_bf16_f32 v116, v232, v233
  v_cvt_pk_bf16_f32 v117, v234, v235
  v_cvt_pk_bf16_f32 v118, v236, v237
  v_cvt_pk_bf16_f32 v119, v238, v239
  buffer_store_dwordx4 v[112:115], v8, s[8:11], s44 offen offset:0 sc1
  buffer_store_dwordx4 v[116:119], v8, s[8:11], s44 offen offset:1024 sc1
P3_FIN:
  s_waitcnt lgkmcnt(0)
  s_lshl_b32 s38, s36, 8
  s_add_u32 s38, s38, 229376
  s_waitcnt vmcnt(0)
  v_mov_b32 v0, 0
  v_mov_b32 v1, 1
  s_mov_b64 exec, 1
  buffer_atomic_add v1, v0, s[8:11], s38 offen sc1
  s_mov_b64 exec, -1
C_P4:
  s_bfe_u32 s33, s2, 0x20001
  s_lshl_b32 s33, s33, 3
  s_bfe_u32 s34, s2, 0x30003
  s_add_u32 s33, s33, s34
  s_and_b32 s34, s2, 1
  s_lshl_b32 s34, s34, 2
  s_lshr_b32 s35, s2, 6
  s_add_u32 s34, s34, s35
  s_and_b32 s51, s3, 1
  s_lshr_b32 s52, s3, 1
  s_lshl_b32 s36, s33, 1
  s_add_u32 s36, s36, s51
  s_lshl_b32 s35, s34, 1
  s_add_u32 s35, s35, s52
  v_and_b32 v3, 31, v2
  v_lshrrev_b32 v4, 5, v2
  v_lshlrev_b32 v5, 4, v4
  s_lshl_b32 s41, s36, 15
  s_lshl_b32 s42, s35, 6
  s_add_u32 s41, s41, s42
  v_lshlrev_b32 v6, 10, v3
  v_lshl_add_u32 v6, v4, 3, v6
  s_lshl_b32 s42, s36, 15
  s_lshl_b32 s44, s35, 11
  s_add_u32 s42, s42, s44
  s_add_u32 s42, s42, 8388608
  s_lshl_b32 s43, s35, 7
  s_add_u32 s43, s43, 10240
  buffer_load_dwordx4 v[128:131], v5, s[8:11], s43 offen offset:0
  buffer_load_dwordx4 v[132:135], v5, s[8:11], s43 offen offset:32
  buffer_load_dwordx4 v[136:139], v5, s[8:11], s43 offen offset:64
  buffer_load_dwordx4 v[140:143], v5, s[8:11], s43 offen offset:96
  s_lshl_b32 s43, s35, 7
  s_add_u32 s43, s43, 22528
  buffer_load_dwordx4 v[144:147], v5, s[8:11], s43 offen offset:0
  buffer_load_dwordx4 v[148:151], v5, s[8:11], s43 offen offset:32
  buffer_load_dwordx4 v[152:155], v5, s[8:11], s43 offen offset:64
  buffer_load_dwordx4 v[156:159], v5, s[8:11], s43 offen offset:96
  s_lshl_b32 s43, s35, 7
  s_add_u32 s43, s43, 34816
  buffer_load_dwordx4 v[160:163], v5, s[8:11], s43 offen offset:0
  buffer_load_dwordx4 v[164:167], v5, s[8:11], s43 offen offset:32
  buffer_load_dwordx4 v[168:171], v5, s[8:11], s43 offen offset:64
  buffer_load_dwordx4 v[172:175], v5, s[8:11], s43 offen offset:96
  s_lshl_b32 s43, s35, 7
  s_add_u32 s43, s43, 47104
  buffer_load_dwordx4 v[176:179], v5, s[8:11], s43 offen offset:0
  buffer_load_dwordx4 v[180:183], v5, s[8:11], s43 offen offset:32
  buffer_load_dwordx4 v[184:187], v5, s[8:11], s43 offen offset:64
  buffer_load_dwordx4 v[188:191], v5, s[8:11], s43 offen offset:96
  s_lshl_b32 s44, s51, 13
  v_add_u32 v9, s44, v8
  s_lshl_b32 s44, s52, 13
  s_add_u32 s44, s44, 16384
  v_add_u32 v10, s44, v8
  v_add_u32 v11, 65536, v9
  v_add_u32 v12, 65536, v10
  s_waitcnt vmcnt(0)
  v_add_f32 v128, v128, v144
  v_add_f32 v160, v160, v176
  v_add_f32 v16, v128, v160
  v_add_f32 v129, v129, v145
  v_add_f32 v161, v161, v177
  v_add_f32 v17, v129, v161
  v_add_f32 v130, v130, v146
  v_add_f32 v162, v162, v178
  v_add_f32 v18, v130, v162
  v_add_f32 v131, v131, v147
  v_add_f32 v163, v163, v179
  v_add_f32 v19, v131, v163
  v_add_f32 v132, v132, v148
  v_add_f32 v164, v164, v180
  v_add_f32 v20, v132, v164
  v_add_f32 v133, v133, v149
  v_add_f32 v165, v165, v181
  v_add_f32 v21, v133, v165
  v_add_f32 v134, v134, v150
  v_add_f32 v166, v166, v182
  v_add_f32 v22, v134, v166
  v_add_f32 v135, v135, v151
  v_add_f32 v167, v167, v183
  v_add_f32 v23, v135, v167
  v_add_f32 v136, v136, v152
  v_add_f32 v168, v168, v184
  v_add_f32 v24, v136, v168
  v_add_f32 v137, v137, v153
  v_add_f32 v169, v169, v185
  v_add_f32 v25, v137, v169
  v_add_f32 v138, v138, v154
  v_add_f32 v170, v170, v186
  v_add_f32 v26, v138, v170
  v_add_f32 v139, v139, v155
  v_add_f32 v171, v171, v187
  v_add_f32 v27, v139, v171
  v_add_f32 v140, v140, v156
  v_add_f32 v172, v172, v188
  v_add_f32 v28, v140, v172
  v_add_f32 v141, v141, v157
  v_add_f32 v173, v173, v189
  v_add_f32 v29, v141, v173
  v_add_f32 v142, v142, v158
  v_add_f32 v174, v174, v190
  v_add_f32 v30, v142, v174
  v_add_f32 v143, v143, v159
  v_add_f32 v175, v175, v191
  v_add_f32 v31, v143, v175
  v_cvt_pk_bf16_f32 v1, v16, v17
  v_lshlrev_b32 v16, 16, v1
  v_and_b32 v17, 0xffff0000, v1
  v_cvt_pk_bf16_f32 v1, v18, v19
  v_lshlrev_b32 v18, 16, v1
  v_and_b32 v19, 0xffff0000, v1
  v_cvt_pk_bf16_f32 v1, v20, v21
  v_lshlrev_b32 v20, 16, v1
  v_and_b32 v21, 0xffff0000, v1
  v_cvt_pk_bf16_f32 v1, v22, v23
  v_lshlrev_b32 v22, 16, v1
  v_and_b32 v23, 0xffff0000, v1
  v_cvt_pk_bf16_f32 v1, v24, v25
  v_lshlrev_b32 v24, 16, v1
  v_and_b32 v25, 0xffff0000, v1
  v_cvt_pk_bf16_f32 v1, v26, v27
  v_lshlrev_b32 v26, 16, v1
  v_and_b32 v27, 0xffff0000, v1
  v_cvt_pk_bf16_f32 v1, v28, v29
  v_lshlrev_b32 v28, 16, v1
  v_and_b32 v29, 0xffff0000, v1
  v_cvt_pk_bf16_f32 v1, v30, v31
  v_lshlrev_b32 v30, 16, v1
  v_and_b32 v31, 0xffff0000, v1
  s_barrier
  s_lshl_b32 s43, s3, 11
  s_add_u32 s43, s43, 155648
  v_add_u32 v7, s43, v8
  ds_read_b128 v[32:35], v7
  ds_read_b128 v[36:39], v7 offset:1024
  ds_read_b128 v[64:67], v10 offset:0
  ds_read_b128 v[68:71], v9 offset:0
  ds_read_b128 v[72:75], v10 offset:1024
  ds_read_b128 v[76:79], v9 offset:1024
  ds_read_b128 v[80:83], v10 offset:2048
  ds_read_b128 v[84:87], v9 offset:2048
  ds_read_b128 v[88:91], v10 offset:3072
  ds_read_b128 v[92:95], v9 offset:3072
  s_waitcnt lgkmcnt(6)
  v_mfma_f32_32x32x16_bf16 v[48:63], v[64:67], v[68:71], 0
  ds_read_b128 v[64:67], v10 offset:4096
  ds_read_b128 v[68:71], v9 offset:4096
  s_waitcnt lgkmcnt(6)
  v_mfma_f32_32x32x16_bf16 v[48:63], v[72:75], v[76:79], v[48:63]
  ds_read_b128 v[72:75], v10 offset:5120
  ds_read_b128 v[76:79], v9 offset:5120
  s_waitcnt lgkmcnt(6)
  v_mfma_f32_32x32x16_bf16 v[48:63], v[80:83], v[84:87], v[48:63]
  ds_read_b128 v[80:83], v10 offset:6144
  ds_read_b128 v[84:87], v9 offset:6144
  s_waitcnt lgkmcnt(6)
  v_mfma_f32_32x32x16_bf16 v[48:63], v[88:91], v[92:95], v[48:63]
  ds_read_b128 v[88:91], v10 offset:7168
  ds_read_b128 v[92:95], v9 offset:7168
  s_waitcnt lgkmcnt(6)
  v_mfma_f32_32x32x16_bf16 v[48:63], v[64:67], v[68:71], v[48:63]
  s_barrier
  ds_read_b128 v[64:67], v10 offset:32768
  ds_read_b128 v[68:71], v9 offset:32768
  s_waitcnt lgkmcnt(6)
  v_mfma_f32_32x32x16_bf16 v[48:63], v[72:75], v[76:79], v[48:63]
  ds_read_b128 v[72:75], v10 offset:33792
  ds_read_b128 v[76:79], v9 offset:33792
  s_waitcnt lgkmcnt(6)
  v_mfma_f32_32x32x16_bf16 v[48:63], v[80:83], v[84:87], v[48:63]
  ds_read_b128 v[80:83], v10 offset:34816
  ds_read_b128 v[84:87], v9 offset:34816
  s_waitcnt lgkmcnt(6)
  v_mfma_f32_32x32x16_bf16 v[48:63], v[88:91], v[92:95], v[48:63]
  ds_read_b128 v[88:91], v10 offset:35840
  ds_read_b128 v[92:95], v9 offset:35840
  s_waitcnt lgkmcnt(6)
  v_mfma_f32_32x32x16_bf16 v[48:63], v[64:67], v[68:71], v[48:63]
  ds_read_b128 v[64:67], v10 offset:36864
  ds_read_b128 v[68:71], v9 offset:36864
  s_waitcnt lgkmcnt(6)
  v_mfma_f32_32x32x16_bf16 v[48:63], v[72:75], v[76:79], v[48:63]
  ds_read_b128 v[72:75], v10 offset:37888
  ds_read_b128 v[76:79], v9 offset:37888
  s_waitcnt lgkmcnt(6)
  v_mfma_f32_32x32x16_bf16 v[48:63], v[80:83], v[84:87], v[48:63]
  ds_read_b128 v[80:83], v10 offset:38912
  ds_read_b128 v[84:87], v9 offset:38912
  s_waitcnt lgkmcnt(6)
  v_mfma_f32_32x32x16_bf16 v[48:63], v[88:91], v[92:95], v[48:63]
  ds_read_b128 v[88:91], v10 offset:39936
  ds_read_b128 v[92:95], v9 offset:39936
  s_waitcnt lgkmcnt(6)
  v_mfma_f32_32x32x16_bf16 v[48:63], v[64:67], v[68:71], v[48:63]
  s_barrier
  ds_read_b128 v[64:67], v12 offset:0
  ds_read_b128 v[68:71], v11 offset:0
  s_waitcnt lgkmcnt(6)
  v_mfma_f32_32x32x16_bf16 v[48:63], v[72:75], v[76:79], v[48:63]
  ds_read_b128 v[72:75], v12 offset:1024
  ds_read_b128 v[76:79], v11 offset:1024
  s_waitcnt lgkmcnt(6)
  v_mfma_f32_32x32x16_bf16 v[48:63], v[80:83], v[84:87], v[48:63]
  ds_read_b128 v[80:83], v12 offset:2048
  ds_read_b128 v[84:87], v11 offset:2048
  s_waitcnt lgkmcnt(6)
  v_mfma_f32_32x32x16_bf16 v[48:63], v[88:91], v[92:95], v[48:63]
  ds_read_b128 v[88:91], v12 offset:3072
  ds_read_b128 v[92:95], v11 offset:3072
  s_waitcnt lgkmcnt(6)
  v_mfma_f32_32x32x16_bf16 v[48:63], v[64:67], v[68:71], v[48:63]
  ds_read_b128 v[64:67], v12 offset:4096
  ds_read_b128 v[68:71], v11 offset:4096
  s_waitcnt lgkmcnt(6)
  v_mfma_f32_32x32x16_bf16 v[48:63], v[72:75], v[76:79], v[48:63]
  ds_read_b128 v[72:75], v12 offset:5120
  ds_read_b128 v[76:79], v11 offset:5120
  s_waitcnt lgkmcnt(6)
  v_mfma_f32_32x32x16_bf16 v[48:63], v[80:83], v[84:87], v[48:63]
  ds_read_b128 v[80:83], v12 offset:6144
  ds_read_b128 v[84:87], v11 offset:6144
  s_waitcnt lgkmcnt(6)
  v_mfma_f32_32x32x16_bf16 v[48:63], v[88:91], v[92:95], v[48:63]
  ds_read_b128 v[88:91], v12 offset:7168
  ds_read_b128 v[92:95], v11 offset:7168
  s_waitcnt lgkmcnt(6)
  v_mfma_f32_32x32x16_bf16 v[48:63], v[64:67], v[68:71], v[48:63]
  s_barrier
  ds_read_b128 v[64:67], v12 offset:32768
  ds_read_b128 v[68:71], v11 offset:32768
  s_waitcnt lgkmcnt(6)
  v_mfma_f32_32x32x16_bf16 v[48:63], v[72:75], v[76:79], v[48:63]
  ds_read_b128 v[72:75], v12 offset:33792
  ds_read_b128 v[76:79], v11 offset:33792
  s_waitcnt lgkmcnt(6)
  v_mfma_f32_32x32x16_bf16 v[48:63], v[80:83], v[84:87], v[48:63]
  ds_read_b128 v[80:83], v12 offset:34816
  ds_read_b128 v[84:87], v11 offset:34816
  s_waitcnt lgkmcnt(6)
  v_mfma_f32_32x32x16_bf16 v[48:63], v[88:91], v[92:95], v[48:63]
  ds_read_b128 v[88:91], v12 offset:35840
  ds_read_b128 v[92:95], v11 offset:35840
  s_waitcnt lgkmcnt(6)
  v_mfma_f32_32x32x16_bf16 v[48:63], v[64:67], v[68:71], v[48:63]
  ds_read_b128 v[64:67], v12 offset:36864
  ds_read_b128 v[68:71], v11 offset:36864
  s_waitcnt lgkmcnt(6)
  v_mfma_f32_32x32x16_bf16 v[48:63], v[72:75], v[76:79], v[48:63]
  ds_read_b128 v[72:75], v12 offset:37888
  ds_read_b128 v[76:79], v11 offset:37888
  s_waitcnt lgkmcnt(6)
  v_mfma_f32_32x32x16_bf16 v[48:63], v[80:83], v[84:87], v[48:63]
  ds_read_b128 v[80:83], v12 offset:38912
  ds_read_b128 v[84:87], v11 offset:38912
  s_waitcnt lgkmcnt(6)
  v_mfma_f32_32x32x16_bf16 v[48:63], v[88:91], v[92:95], v[48:63]
  ds_read_b128 v[88:91], v12 offset:39936
  ds_read_b128 v[92:95], v11 offset:39936
  s_waitcnt lgkmcnt(6)
  v_mfma_f32_32x32x16_bf16 v[48:63], v[64:67], v[68:71], v[48:63]
  s_barrier
  ds_read_b128 v[64:67], v10 offset:0
  ds_read_b128 v[68:71], v9 offset:0
  s_waitcnt lgkmcnt(6)
  v_mfma_f32_32x32x16_bf16 v[48:63], v[72:75], v[76:79], v[48:63]
  ds_read_b128 v[72:75], v10 offset:1024
  ds_read_b128 v[76:79], v9 offset:1024
  s_waitcnt lgkmcnt(6)
  v_mfma_f32_32x32x16_bf16 v[48:63], v[80:83], v[84:87], v[48:63]
  ds_read_b128 v[80:83], v10 offset:2048
  ds_read_b128 v[84:87], v9 offset:2048
  s_waitcnt lgkmcnt(6)
  v_mfma_f32_32x32x16_bf16 v[48:63], v[88:91], v[92:95], v[48:63]
  ds_read_b128 v[88:91], v10 offset:3072
  ds_read_b128 v[92:95], v9 offset:3072
  s_waitcnt lgkmcnt(6)
  v_mfma_f32_32x32x16_bf16 v[48:63], v[64:67], v[68:71], v[48:63]
  ds_read_b128 v[64:67], v10 offset:4096
  ds_read_b128 v[68:71], v9 offset:4096
  s_waitcnt lgkmcnt(6)
  v_mfma_f32_32x32x16_bf16 v[48:63], v[72:75], v[76:79], v[48:63]
  ds_read_b128 v[72:75], v10 offset:5120
  ds_read_b128 v[76:79], v9 offset:5120
  s_waitcnt lgkmcnt(6)
  v_mfma_f32_32x32x16_bf16 v[48:63], v[80:83], v[84:87], v[48:63]
  ds_read_b128 v[80:83], v10 offset:6144
  ds_read_b128 v[84:87], v9 offset:6144
  s_waitcnt lgkmcnt(6)
  v_mfma_f32_32x32x16_bf16 v[48:63], v[88:91], v[92:95], v[48:63]
  ds_read_b128 v[88:91], v10 offset:7168
  ds_read_b128 v[92:95], v9 offset:7168
  s_waitcnt lgkmcnt(6)
  v_mfma_f32_32x32x16_bf16 v[48:63], v[64:67], v[68:71], v[48:63]
  s_barrier
  ds_read_b128 v[64:67], v10 offset:32768
  ds_read_b128 v[68:71], v9 offset:32768
  s_waitcnt lgkmcnt(6)
  v_mfma_f32_32x32x16_bf16 v[48:63], v[72:75], v[76:79], v[48:63]
  ds_read_b128 v[72:75], v10 offset:33792
  ds_read_b128 v[76:79], v9 offset:33792
  s_waitcnt lgkmcnt(6)
  v_mfma_f32_32x32x16_bf16 v[48:63], v[80:83], v[84:87], v[48:63]
  ds_read_b128 v[80:83], v10 offset:34816
  ds_read_b128 v[84:87], v9 offset:34816
  s_waitcnt lgkmcnt(6)
  v_mfma_f32_32x32x16_bf16 v[48:63], v[88:91], v[92:95], v[48:63]
  ds_read_b128 v[88:91], v10 offset:35840
  ds_read_b128 v[92:95], v9 offset:35840
  s_waitcnt lgkmcnt(6)
  v_mfma_f32_32x32x16_bf16 v[48:63], v[64:67], v[68:71], v[48:63]
  ds_read_b128 v[64:67], v10 offset:36864
  ds_read_b128 v[68:71], v9 offset:36864
  s_waitcnt lgkmcnt(6)
  v_mfma_f32_32x32x16_bf16 v[48:63], v[72:75], v[76:79], v[48:63]
  ds_read_b128 v[72:75], v10 offset:37888
  ds_read_b128 v[76:79], v9 offset:37888
  s_waitcnt lgkmcnt(6)
  v_mfma_f32_32x32x16_bf16 v[48:63], v[80:83], v[84:87], v[48:63]
  ds_read_b128 v[80:83], v10 offset:38912
  ds_read_b128 v[84:87], v9 offset:38912
  s_waitcnt lgkmcnt(6)
  v_mfma_f32_32x32x16_bf16 v[48:63], v[88:91], v[92:95], v[48:63]
  ds_read_b128 v[88:91], v10 offset:39936
  ds_read_b128 v[92:95], v9 offset:39936
  s_waitcnt lgkmcnt(6)
  v_mfma_f32_32x32x16_bf16 v[48:63], v[64:67], v[68:71], v[48:63]
  s_barrier
  ds_read_b128 v[64:67], v12 offset:0
  ds_read_b128 v[68:71], v11 offset:0
  s_waitcnt lgkmcnt(6)
  v_mfma_f32_32x32x16_bf16 v[48:63], v[72:75], v[76:79], v[48:63]
  ds_read_b128 v[72:75], v12 offset:1024
  ds_read_b128 v[76:79], v11 offset:1024
  s_waitcnt lgkmcnt(6)
  v_mfma_f32_32x32x16_bf16 v[48:63], v[80:83], v[84:87], v[48:63]
  ds_read_b128 v[80:83], v12 offset:2048
  ds_read_b128 v[84:87], v11 offset:2048
  s_waitcnt lgkmcnt(6)
  v_mfma_f32_32x32x16_bf16 v[48:63], v[88:91], v[92:95], v[48:63]
  ds_read_b128 v[88:91], v12 offset:3072
  ds_read_b128 v[92:95], v11 offset:3072
  s_waitcnt lgkmcnt(6)
  v_mfma_f32_32x32x16_bf16 v[48:63], v[64:67], v[68:71], v[48:63]
  ds_read_b128 v[64:67], v12 offset:4096
  ds_read_b128 v[68:71], v11 offset:4096
  s_waitcnt lgkmcnt(6)
  v_mfma_f32_32x32x16_bf16 v[48:63], v[72:75], v[76:79], v[48:63]
  ds_read_b128 v[72:75], v12 offset:5120
  ds_read_b128 v[76:79], v11 offset:5120
  s_waitcnt lgkmcnt(6)
  v_mfma_f32_32x32x16_bf16 v[48:63], v[80:83], v[84:87], v[48:63]
  ds_read_b128 v[80:83], v12 offset:6144
  ds_read_b128 v[84:87], v11 offset:6144
  s_waitcnt lgkmcnt(6)
  v_mfma_f32_32x32x16_bf16 v[48:63], v[88:91], v[92:95], v[48:63]
  ds_read_b128 v[88:91], v12 offset:7168
  ds_read_b128 v[92:95], v11 offset:7168
  s_waitcnt lgkmcnt(6)
  v_mfma_f32_32x32x16_bf16 v[48:63], v[64:67], v[68:71], v[48:63]
  s_barrier
  ds_read_b128 v[64:67], v12 offset:32768
  ds_read_b128 v[68:71], v11 offset:32768
  s_waitcnt lgkmcnt(6)
  v_mfma_f32_32x32x16_bf16 v[48:63], v[72:75], v[76:79], v[48:63]
  ds_read_b128 v[72:75], v12 offset:33792
  ds_read_b128 v[76:79], v11 offset:33792
  s_waitcnt lgkmcnt(6)
  v_mfma_f32_32x32x16_bf16 v[48:63], v[80:83], v[84:87], v[48:63]
  ds_read_b128 v[80:83], v12 offset:34816
  ds_read_b128 v[84:87], v11 offset:34816
  s_waitcnt lgkmcnt(6)
  v_mfma_f32_32x32x16_bf16 v[48:63], v[88:91], v[92:95], v[48:63]
  ds_read_b128 v[88:91], v12 offset:35840
  ds_read_b128 v[92:95], v11 offset:35840
  s_waitcnt lgkmcnt(6)
  v_mfma_f32_32x32x16_bf16 v[48:63], v[64:67], v[68:71], v[48:63]
  ds_read_b128 v[64:67], v12 offset:36864
  ds_read_b128 v[68:71], v11 offset:36864
  s_waitcnt lgkmcnt(6)
  v_mfma_f32_32x32x16_bf16 v[48:63], v[72:75], v[76:79], v[48:63]
  ds_read_b128 v[72:75], v12 offset:37888
  ds_read_b128 v[76:79], v11 offset:37888
  s_waitcnt lgkmcnt(6)
  v_mfma_f32_32x32x16_bf16 v[48:63], v[80:83], v[84:87], v[48:63]
  ds_read_b128 v[80:83], v12 offset:38912
  ds_read_b128 v[84:87], v11 offset:38912
  s_waitcnt lgkmcnt(6)
  v_mfma_f32_32x32x16_bf16 v[48:63], v[88:91], v[92:95], v[48:63]
  ds_read_b128 v[88:91], v12 offset:39936
  ds_read_b128 v[92:95], v11 offset:39936
  s_waitcnt lgkmcnt(6)
  v_mfma_f32_32x32x16_bf16 v[48:63], v[64:67], v[68:71], v[48:63]
  s_barrier
  ds_read_b128 v[64:67], v10 offset:0
  ds_read_b128 v[68:71], v9 offset:0
  s_waitcnt lgkmcnt(6)
  v_mfma_f32_32x32x16_bf16 v[48:63], v[72:75], v[76:79], v[48:63]
  ds_read_b128 v[72:75], v10 offset:1024
  ds_read_b128 v[76:79], v9 offset:1024
  s_waitcnt lgkmcnt(6)
  v_mfma_f32_32x32x16_bf16 v[48:63], v[80:83], v[84:87], v[48:63]
  ds_read_b128 v[80:83], v10 offset:2048
  ds_read_b128 v[84:87], v9 offset:2048
  s_waitcnt lgkmcnt(6)
  v_mfma_f32_32x32x16_bf16 v[48:63], v[88:91], v[92:95], v[48:63]
  ds_read_b128 v[88:91], v10 offset:3072
  ds_read_b128 v[92:95], v9 offset:3072
  s_waitcnt lgkmcnt(6)
  v_mfma_f32_32x32x16_bf16 v[48:63], v[64:67], v[68:71], v[48:63]
  ds_read_b128 v[64:67], v10 offset:4096
  ds_read_b128 v[68:71], v9 offset:4096
  s_waitcnt lgkmcnt(6)
  v_mfma_f32_32x32x16_bf16 v[48:63], v[72:75], v[76:79], v[48:63]
  ds_read_b128 v[72:75], v10 offset:5120
  ds_read_b128 v[76:79], v9 offset:5120
  s_waitcnt lgkmcnt(6)
  v_mfma_f32_32x32x16_bf16 v[48:63], v[80:83], v[84:87], v[48:63]
  ds_read_b128 v[80:83], v10 offset:6144
  ds_read_b128 v[84:87], v9 offset:6144
  s_waitcnt lgkmcnt(6)
  v_mfma_f32_32x32x16_bf16 v[48:63], v[88:91], v[92:95], v[48:63]
  ds_read_b128 v[88:91], v10 offset:7168
  ds_read_b128 v[92:95], v9 offset:7168
  s_waitcnt lgkmcnt(6)
  v_mfma_f32_32x32x16_bf16 v[48:63], v[64:67], v[68:71], v[48:63]
  s_barrier
  ds_read_b128 v[64:67], v10 offset:32768
  ds_read_b128 v[68:71], v9 offset:32768
  s_waitcnt lgkmcnt(6)
  v_mfma_f32_32x32x16_bf16 v[48:63], v[72:75], v[76:79], v[48:63]
  ds_read_b128 v[72:75], v10 offset:33792
  ds_read_b128 v[76:79], v9 offset:33792
  s_waitcnt lgkmcnt(6)
  v_mfma_f32_32x32x16_bf16 v[48:63], v[80:83], v[84:87], v[48:63]
  ds_read_b128 v[80:83], v10 offset:34816
  ds_read_b128 v[84:87], v9 offset:34816
  s_waitcnt lgkmcnt(6)
  v_mfma_f32_32x32x16_bf16 v[48:63], v[88:91], v[92:95], v[48:63]
  ds_read_b128 v[88:91], v10 offset:35840
  ds_read_b128 v[92:95], v9 offset:35840
  s_waitcnt lgkmcnt(6)
  v_mfma_f32_32x32x16_bf16 v[48:63], v[64:67], v[68:71], v[48:63]
  ds_read_b128 v[64:67], v10 offset:36864
  ds_read_b128 v[68:71], v9 offset:36864
  s_waitcnt lgkmcnt(6)
  v_mfma_f32_32x32x16_bf16 v[48:63], v[72:75], v[76:79], v[48:63]
  ds_read_b128 v[72:75], v10 offset:37888
  ds_read_b128 v[76:79], v9 offset:37888
  s_waitcnt lgkmcnt(6)
  v_mfma_f32_32x32x16_bf16 v[48:63], v[80:83], v[84:87], v[48:63]
  ds_read_b128 v[80:83], v10 offset:38912
  ds_read_b128 v[84:87], v9 offset:38912
  s_waitcnt lgkmcnt(6)
  v_mfma_f32_32x32x16_bf16 v[48:63], v[88:91], v[92:95], v[48:63]
  ds_read_b128 v[88:91], v10 offset:39936
  ds_read_b128 v[92:95], v9 offset:39936
  s_waitcnt lgkmcnt(6)
  v_mfma_f32_32x32x16_bf16 v[48:63], v[64:67], v[68:71], v[48:63]
  s_barrier
  ds_read_b128 v[64:67], v12 offset:0
  ds_read_b128 v[68:71], v11 offset:0
  s_waitcnt lgkmcnt(6)
  v_mfma_f32_32x32x16_bf16 v[48:63], v[72:75], v[76:79], v[48:63]
  ds_read_b128 v[72:75], v12 offset:1024
  ds_read_b128 v[76:79], v11 offset:1024
  s_waitcnt lgkmcnt(6)
  v_mfma_f32_32x32x16_bf16 v[48:63], v[80:83], v[84:87], v[48:63]
  ds_read_b128 v[80:83], v12 offset:2048
  ds_read_b128 v[84:87], v11 offset:2048
  s_waitcnt lgkmcnt(6)
  v_mfma_f32_32x32x16_bf16 v[48:63], v[88:91], v[92:95], v[48:63]
  ds_read_b128 v[88:91], v12 offset:3072
  ds_read_b128 v[92:95], v11 offset:3072
  s_waitcnt lgkmcnt(6)
  v_mfma_f32_32x32x16_bf16 v[48:63], v[64:67], v[68:71], v[48:63]
  v_lshlrev_b32 v96, 16, v32
  v_and_b32 v97, 0xffff0000, v32
  v_lshlrev_b32 v98, 16, v33
  v_and_b32 v99, 0xffff0000, v33
  v_lshlrev_b32 v100, 16, v34
  v_and_b32 v101, 0xffff0000, v34
  v_lshlrev_b32 v102, 16, v35
  v_and_b32 v103, 0xffff0000, v35
  v_lshlrev_b32 v104, 16, v36
  v_and_b32 v105, 0xffff0000, v36
  v_lshlrev_b32 v106, 16, v37
  v_and_b32 v107, 0xffff0000, v37
  v_lshlrev_b32 v108, 16, v38
  v_and_b32 v109, 0xffff0000, v38
  v_lshlrev_b32 v110, 16, v39
  v_and_b32 v111, 0xffff0000, v39
  ds_read_b128 v[64:67], v12 offset:4096
  ds_read_b128 v[68:71], v11 offset:4096
  s_waitcnt lgkmcnt(6)
  v_mfma_f32_32x32x16_bf16 v[48:63], v[72:75], v[76:79], v[48:63]
  ds_read_b128 v[72:75], v12 offset:5120
  ds_read_b128 v[76:79], v11 offset:5120
  s_waitcnt lgkmcnt(6)
  v_mfma_f32_32x32x16_bf16 v[48:63], v[80:83], v[84:87], v[48:63]
  s_waitcnt lgkmcnt(4)
  v_mfma_f32_32x32x16_bf16 v[48:63], v[88:91], v[92:95], v[48:63]
  s_waitcnt lgkmcnt(2)
  v_mfma_f32_32x32x16_bf16 v[48:63], v[64:67], v[68:71], v[48:63]
  s_waitcnt lgkmcnt(0)
  v_mfma_f32_32x32x16_bf16 v[48:63], v[72:75], v[76:79], v[48:63]
  s_nop 11
  v_fmac_f32 v96, v48, v16
  v_fmac_f32 v97, v49, v17
  v_fmac_f32 v98, v50, v18
  v_fmac_f32 v99, v51, v19
  v_fmac_f32 v100, v52, v20
  v_fmac_f32 v101, v53, v21
  v_fmac_f32 v102, v54, v22
  v_fmac_f32 v103, v55, v23
  v_fmac_f32 v104, v56, v24
  v_fmac_f32 v105, v57, v25
  v_fmac_f32 v106, v58, v26
  v_fmac_f32 v107, v59, v27
  v_fmac_f32 v108, v60, v28
  v_fmac_f32 v109, v61, v29
  v_fmac_f32 v110, v62, v30
  v_fmac_f32 v111, v63, v31
  v_cvt_pk_bf16_f32 v84, v96, v97
  v_cvt_pk_bf16_f32 v85, v98, v99
  v_cvt_pk_bf16_f32 v86, v100, v101
  v_cvt_pk_bf16_f32 v87, v102, v103
  v_cvt_pk_bf16_f32 v88, v104, v105
  v_cvt_pk_bf16_f32 v89, v106, v107
  v_cvt_pk_bf16_f32 v90, v108, v109
  v_cvt_pk_bf16_f32 v91, v110, v111
  v_permlane32_swap_b32 v84, v86
  v_permlane32_swap_b32 v85, v87
  v_permlane32_swap_b32 v88, v90
  v_permlane32_swap_b32 v89, v91
  v_lshlrev_b32 v6, 10, v3
  v_lshl_add_u32 v6, v4, 4, v6
  buffer_store_dwordx4 v[84:87], v6, s[16:19], s41 offen
  buffer_store_dwordx4 v[88:91], v6, s[16:19], s41 offen offset:32
  s_endpgm
KM_LOADER:
  s_mul_i32 s39, s50, 3072
  s_mul_i32 s38, s34, 98304
  s_add_u32 s38, s38, 3145728
  s_add_u32 s38, s38, s39
  s_mov_b32 s40, s39
  v_and_b32 v4, 15, v2
  v_lshrrev_b32 v5, 4, v2
  v_lshrrev_b32 v6, 1, v5
  v_and_b32 v7, 1, v5
  v_lshlrev_b32 v9, 10, v6
  v_lshl_add_u32 v9, v7, 9, v9
  v_lshl_add_u32 v9, v4, 4, v9
  v_add_u32 v9, 256, v9
  s_lshl_b32 s41, s33, 2
  s_sub_u32 s41, s41, 1
  s_max_i32 s41, s41, 0
  s_lshl_b32 s41, s41, 15
  s_lshl_b32 s43, s50, 11
  s_add_u32 s41, s41, s43
  s_add_u32 s41, s41, 1048576
  v_mul_u32_u24 v13, 3072, v6
  v_lshl_add_u32 v13, v7, 9, v13
  v_lshl_add_u32 v13, v4, 4, v13
  s_lshr_b32 s43, s50, 1
  s_add_u32 s43, s43, 1
  s_lshl_b32 s43, s43, 10
  s_and_b32 s44, s50, 1
  s_lshl_b32 s44, s44, 8
  s_add_u32 s43, s43, s44
  v_add_u32 v13, s43, v13
  v_add_u32 v14, 49152, v13
  v_lshlrev_b32 v12, 5, v5
  s_lshl_b32 s43, s50, 7
  v_add_u32 v12, s43, v12
  v_add_u32 v12, 98304, v12
  v_add_u32 v10, 102400, v8
  s_lshl_b32 s43, s50, 10
  v_add_u32 v11, s43, v10
  s_mov_b32 m0, s40
  s_nop 0
  buffer_load_dwordx4 v8, s[8:11], s38 offen offset:0 lds
  buffer_load_dwordx4 v8, s[8:11], s38 offen offset:1024 lds
  buffer_load_dwordx4 v8, s[8:11], s38 offen offset:2048 lds
  s_add_u32 s38, s38, 12288
  s_add_u32 s40, s40, 12288
  s_mov_b32 m0, s40
  s_nop 0
  buffer_load_dwordx4 v8, s[8:11], s38 offen offset:0 lds
  buffer_load_dwordx4 v8, s[8:11], s38 offen offset:1024 lds
  buffer_load_dwordx4 v8, s[8:11], s38 offen offset:2048 lds
  s_add_u32 s38, s38, 12288
  s_add_u32 s40, s40, 12288
  buffer_load_dwordx4 v[100:103], v9, s[8:11], s41 offen
  s_add_u32 s41, s41, 8192
  buffer_load_dwordx4 v[104:107], v9, s[8:11], s41 offen
  s_add_u32 s41, s41, 8192
  buffer_load_dwordx4 v[108:111], v9, s[8:11], s41 offen
  s_add_u32 s41, s41, 8192
  buffer_load_dwordx4 v[112:115], v9, s[8:11], s41 offen
  s_add_u32 s41, s41, 8192
  s_mov_b32 m0, s40
  s_nop 0
  buffer_load_dwordx4 v8, s[8:11], s38 offen offset:0 lds
  buffer_load_dwordx4 v8, s[8:11], s38 offen offset:1024 lds
  buffer_load_dwordx4 v8, s[8:11], s38 offen offset:2048 lds
  s_add_u32 s38, s38, 12288
  s_add_u32 s40, s40, 12288
  s_mov_b32 m0, s40
  s_nop 0
  buffer_load_dwordx4 v8, s[8:11], s38 offen offset:0 lds
  buffer_load_dwordx4 v8, s[8:11], s38 offen offset:1024 lds
  buffer_load_dwordx4 v8, s[8:11], s38 offen offset:2048 lds
  s_add_u32 s38, s38, 12288
  s_add_u32 s40, s40, 12288
  s_waitcnt vmcnt(13)
  s_barrier
  s_mov_b32 m0, s40
  s_nop 0
  buffer_load_dwordx4 v8, s[8:11], s38 offen offset:0 lds
  buffer_load_dwordx4 v8, s[8:11], s38 offen offset:1024 lds
  buffer_load_dwordx4 v8, s[8:11], s38 offen offset:2048 lds
  s_add_u32 s38, s38, 12288
  s_add_u32 s40, s40, 12288
  ds_read_b128 v[32:35], v12 offset:0
  ds_read_b128 v[36:39], v12 offset:16
  ds_read_b128 v[40:43], v12 offset:2048
  ds_read_b128 v[44:47], v12 offset:2064
  s_waitcnt vmcnt(9) lgkmcnt(0)
  v_lshlrev_b32 v16, 16, v100
  v_and_b32 v17, 0xffff0000, v100
  v_lshlrev_b32 v18, 16, v101
  v_and_b32 v19, 0xffff0000, v101
  v_lshlrev_b32 v20, 16, v102
  v_and_b32 v21, 0xffff0000, v102
  v_lshlrev_b32 v22, 16, v103
  v_and_b32 v23, 0xffff0000, v103
  v_fma_f32 v16, v16, v32, v40
  v_fma_f32 v17, v17, v33, v41
  v_fma_f32 v18, v18, v34, v42
  v_fma_f32 v19, v19, v35, v43
  v_fma_f32 v20, v20, v36, v44
  v_fma_f32 v21, v21, v37, v45
  v_fma_f32 v22, v22, v38, v46
  v_fma_f32 v23, v23, v39, v47
  v_cvt_pk_bf16_f32 v100, v16, v17
  v_cvt_pk_bf16_f32 v101, v18, v19
  v_cvt_pk_bf16_f32 v102, v20, v21
  v_cvt_pk_bf16_f32 v103, v22, v23
  ds_write_b128 v11, v[100:103] offset:0
  s_waitcnt lgkmcnt(0)
  s_barrier
  s_mov_b32 m0, s40
  s_nop 0
  buffer_load_dwordx4 v8, s[8:11], s38 offen offset:0 lds
  buffer_load_dwordx4 v8, s[8:11], s38 offen offset:1024 lds
  buffer_load_dwordx4 v8, s[8:11], s38 offen offset:2048 lds
  s_add_u32 s38, s38, 12288
  s_add_u32 s40, s40, 12288
  ds_read_b128 v[32:35], v12 offset:512
  ds_read_b128 v[36:39], v12 offset:528
  ds_read_b128 v[40:43], v12 offset:2560
  ds_read_b128 v[44:47], v12 offset:2576
  ds_read_b128 v[64:67], v13 offset:0
  ds_read_b128 v[68:71], v10 offset:0
  ds_read_b128 v[72:75], v13 offset:6144
  ds_read_b128 v[76:79], v10 offset:1024
  s_waitcnt lgkmcnt(0)
  v_mfma_f32_16x16x32_bf16 v[116:119], v[64:67], v[68:71], 0
  v_mfma_f32_16x16x32_bf16 v[116:119], v[72:75], v[76:79], v[116:119]
  v_lshlrev_b32 v16, 16, v104
  v_and_b32 v17, 0xffff0000, v104
  v_lshlrev_b32 v18, 16, v105
  v_and_b32 v19, 0xffff0000, v105
  v_lshlrev_b32 v20, 16, v106
  v_and_b32 v21, 0xffff0000, v106
  v_lshlrev_b32 v22, 16, v107
  v_and_b32 v23, 0xffff0000, v107
  v_fma_f32 v16, v16, v32, v40
  v_fma_f32 v17, v17, v33, v41
  v_fma_f32 v18, v18, v34, v42
  v_fma_f32 v19, v19, v35, v43
  v_fma_f32 v20, v20, v36, v44
  v_fma_f32 v21, v21, v37, v45
  v_fma_f32 v22, v22, v38, v46
  v_fma_f32 v23, v23, v39, v47
  v_cvt_pk_bf16_f32 v104, v16, v17
  v_cvt_pk_bf16_f32 v105, v18, v19
  v_cvt_pk_bf16_f32 v106, v20, v21
  v_cvt_pk_bf16_f32 v107, v22, v23
  ds_write_b128 v11, v[104:107] offset:4096
  s_waitcnt vmcnt(9) lgkmcnt(0)
  s_barrier
  s_mov_b32 m0, s40
  s_nop 0
  buffer_load_dwordx4 v8, s[8:11], s38 offen offset:0 lds
  buffer_load_dwordx4 v8, s[8:11], s38 offen offset:1024 lds
  buffer_load_dwordx4 v8, s[8:11], s38 offen offset:2048 lds
  s_add_u32 s38, s38, 12288
  s_add_u32 s40, s40, 12288
  ds_read_b128 v[32:35], v12 offset:1024
  ds_read_b128 v[36:39], v12 offset:1040
  ds_read_b128 v[40:43], v12 offset:3072
  ds_read_b128 v[44:47], v12 offset:3088
  ds_read_b128 v[64:67], v13 offset:12288
  ds_read_b128 v[68:71], v10 offset:2048
  ds_read_b128 v[72:75], v13 offset:18432
  ds_read_b128 v[76:79], v10 offset:3072
  s_waitcnt lgkmcnt(0)
  v_mfma_f32_16x16x32_bf16 v[116:119], v[64:67], v[68:71], v[116:119]
  v_mfma_f32_16x16x32_bf16 v[116:119], v[72:75], v[76:79], v[116:119]
  v_lshlrev_b32 v16, 16, v108
  v_and_b32 v17, 0xffff0000, v108
  v_lshlrev_b32 v18, 16, v109
  v_and_b32 v19, 0xffff0000, v109
  v_lshlrev_b32 v20, 16, v110
  v_and_b32 v21, 0xffff0000, v110
  v_lshlrev_b32 v22, 16, v111
  v_and_b32 v23, 0xffff0000, v111
  v_fma_f32 v16, v16, v32, v40
  v_fma_f32 v17, v17, v33, v41
  v_fma_f32 v18, v18, v34, v42
  v_fma_f32 v19, v19, v35, v43
  v_fma_f32 v20, v20, v36, v44
  v_fma_f32 v21, v21, v37, v45
  v_fma_f32 v22, v22, v38, v46
  v_fma_f32 v23, v23, v39, v47
  v_cvt_pk_bf16_f32 v108, v16, v17
  v_cvt_pk_bf16_f32 v109, v18, v19
  v_cvt_pk_bf16_f32 v110, v20, v21
  v_cvt_pk_bf16_f32 v111, v22, v23
  ds_write_b128 v11, v[108:111] offset:8192
  s_waitcnt vmcnt(9) lgkmcnt(0)
  s_barrier
  s_mov_b32 m0, s40
  s_nop 0
  buffer_load_dwordx4 v8, s[8:11], s38 offen offset:0 lds
  buffer_load_dwordx4 v8, s[8:11], s38 offen offset:1024 lds
  buffer_load_dwordx4 v8, s[8:11], s38 offen offset:2048 lds
  s_add_u32 s38, s38, 12288
  s_add_u32 s40, s40, 12288
  s_lshl_b32 s43, s2, 2
  s_add_u32 s43, s43, s50
  s_lshl_b32 s43, s43, 11
  s_mov_b32 s56, s24
  s_and_b32 s57, s25, 0xffff
  s_mov_b32 s58, 1409024
  s_mov_b32 s59, 0x00020000
  buffer_load_dwordx4 v[140:143], v8, s[56:59], s43 offen
  buffer_load_dwordx4 v[140:143], v8, s[56:59], s43 offen offset:1024
  s_mov_b32 s56, s26
  s_and_b32 s57, s27, 0xffff
  s_mov_b32 s58, 1409024
  s_mov_b32 s59, 0x00020000
  buffer_load_dwordx4 v[140:143], v8, s[56:59], s43 offen
  buffer_load_dwordx4 v[140:143], v8, s[56:59], s43 offen offset:1024
  s_mov_b32 s56, s28
  s_and_b32 s57, s29, 0xffff
  s_mov_b32 s58, 1409024
  s_mov_b32 s59, 0x00020000
  buffer_load_dwordx4 v[140:143], v8, s[56:59], s43 offen
  buffer_load_dwordx4 v[140:143], v8, s[56:59], s43 offen offset:1024
  ds_read_b128 v[32:35], v12 offset:1536
  ds_read_b128 v[36:39], v12 offset:1552
  ds_read_b128 v[40:43], v12 offset:3584
  ds_read_b128 v[44:47], v12 offset:3600
  ds_read_b128 v[64:67], v13 offset:24576
  ds_read_b128 v[68:71], v10 offset:4096
  ds_read_b128 v[72:75], v13 offset:30720
  ds_read_b128 v[76:79], v10 offset:5120
  s_waitcnt lgkmcnt(0)
  v_mfma_f32_16x16x32_bf16 v[116:119], v[64:67], v[68:71], v[116:119]
  v_mfma_f32_16x16x32_bf16 v[116:119], v[72:75], v[76:79], v[116:119]
  v_lshlrev_b32 v16, 16, v112
  v_and_b32 v17, 0xffff0000, v112
  v_lshlrev_b32 v18, 16, v113
  v_and_b32 v19, 0xffff0000, v113
  v_lshlrev_b32 v20, 16, v114
  v_and_b32 v21, 0xffff0000, v114
  v_lshlrev_b32 v22, 16, v115
  v_and_b32 v23, 0xffff0000, v115
  v_fma_f32 v16, v16, v32, v40
  v_fma_f32 v17, v17, v33, v41
  v_fma_f32 v18, v18, v34, v42
  v_fma_f32 v19, v19, v35, v43
  v_fma_f32 v20, v20, v36, v44
  v_fma_f32 v21, v21, v37, v45
  v_fma_f32 v22, v22, v38, v46
  v_fma_f32 v23, v23, v39, v47
  v_cvt_pk_bf16_f32 v112, v16, v17
  v_cvt_pk_bf16_f32 v113, v18, v19
  v_cvt_pk_bf16_f32 v114, v20, v21
  v_cvt_pk_bf16_f32 v115, v22, v23
  ds_write_b128 v11, v[112:115] offset:12288
  s_waitcnt vmcnt(15) lgkmcnt(0)
  s_barrier
  ds_read_b128 v[64:67], v13 offset:36864
  ds_read_b128 v[68:71], v10 offset:6144
  ds_read_b128 v[72:75], v13 offset:43008
  ds_read_b128 v[76:79], v10 offset:7168
  s_waitcnt lgkmcnt(0)
  v_mfma_f32_16x16x32_bf16 v[116:119], v[64:67], v[68:71], v[116:119]
  v_mfma_f32_16x16x32_bf16 v[116:119], v[72:75], v[76:79], v[116:119]
  s_waitcnt vmcnt(12)
  s_barrier
  ds_read_b128 v[64:67], v14 offset:0
  ds_read_b128 v[68:71], v10 offset:8192
  ds_read_b128 v[72:75], v14 offset:6144
  ds_read_b128 v[76:79], v10 offset:9216
  s_waitcnt lgkmcnt(0)
  v_mfma_f32_16x16x32_bf16 v[116:119], v[64:67], v[68:71], v[116:119]
  v_mfma_f32_16x16x32_bf16 v[116:119], v[72:75], v[76:79], v[116:119]
  s_waitcnt vmcnt(9)
  s_barrier
  ds_read_b128 v[64:67], v14 offset:12288
  ds_read_b128 v[68:71], v10 offset:10240
  ds_read_b128 v[72:75], v14 offset:18432
  ds_read_b128 v[76:79], v10 offset:11264
  s_waitcnt lgkmcnt(0)
  v_mfma_f32_16x16x32_bf16 v[116:119], v[64:67], v[68:71], v[116:119]
  v_mfma_f32_16x16x32_bf16 v[116:119], v[72:75], v[76:79], v[116:119]
  s_waitcnt vmcnt(6)
  s_barrier
  ds_read_b128 v[64:67], v14 offset:24576
  ds_read_b128 v[68:71], v10 offset:12288
  ds_read_b128 v[72:75], v14 offset:30720
  ds_read_b128 v[76:79], v10 offset:13312
  s_waitcnt lgkmcnt(0)
  v_mfma_f32_16x16x32_bf16 v[116:119], v[64:67], v[68:71], v[116:119]
  v_mfma_f32_16x16x32_bf16 v[116:119], v[72:75], v[76:79], v[116:119]
  s_barrier
  ds_read_b128 v[64:67], v14 offset:36864
  ds_read_b128 v[68:71], v10 offset:14336
  ds_read_b128 v[72:75], v14 offset:43008
  ds_read_b128 v[76:79], v10 offset:15360
  s_waitcnt lgkmcnt(0)
  v_mfma_f32_16x16x32_bf16 v[116:119], v[64:67], v[68:71], v[116:119]
  v_mfma_f32_16x16x32_bf16 v[116:119], v[72:75], v[76:79], v[116:119]
  v_and_b32 v3, 15, v2
  v_lshrrev_b32 v4, 4, v2
  v_and_b32 v5, 1, v4
  v_lshrrev_b32 v6, 1, v4
  s_and_b32 s35, s3, 1
  s_nop 7
  v_cvt_pk_bf16_f32 v84, v116, v117
  v_cvt_pk_bf16_f32 v85, v118, v119
  s_cmp_ge_u32 s50, 2
  s_cbranch_scc1 L_HV
  s_mul_i32 s35, s35, 4608
  v_mul_u32_u24 v5, 2304, v5
  v_lshl_add_u32 v5, v3, 4, v5
  v_lshl_add_u32 v5, v6, 3, v5
  v_add_u32 v5, s35, v5
  v_add_u32 v5, 131072, v5
  ds_write_b64 v5, v[84:85]
  s_branch L_HD
L_HV:
  v_lshlrev_b32 v80, 16, v84
  v_and_b32 v81, 0xffff0000, v84
  v_lshlrev_b32 v82, 16, v85
  v_and_b32 v83, 0xffff0000, v85
  s_mul_i32 s35, s35, 9216
  v_lshl_add_u32 v5, v5, 1, v6
  v_mul_u32_u24 v5, 2304, v5
  v_lshl_add_u32 v5, v3, 4, v5
  v_add_u32 v5, s35, v5
  v_add_u32 v5, 140288, v5
  ds_write_b128 v5, v[80:83]
L_HD:
  s_waitcnt lgkmcnt(0)
  s_barrier
  s_barrier
  s_mov_b32 s55, 0x7ff00000
  s_cmp_ge_u32 s50, 2
  s_cbranch_scc1 RL_END
  s_mov_b32 s40, 0x05040100
  s_mov_b32 s41, 0x07060302
  s_lshl_b32 s52, s2, 1
  s_add_u32 s52, s52, s50
  s_lshl_b32 s45, s50, 15
  s_add_u32 s45, s45, 65536
  s_cmp_ge_u32 s52, 344
  s_cbranch_scc1 RL_W2
  s_and_b32 s44, s52, 3
  s_bfe_u32 s53, s52, 0x10002
  s_lshr_b32 s54, s52, 3
  v_lshrrev_b32 v14, 3, v2
  v_bfe_u32 v4, v2, 2, 1
  v_and_b32 v5, 3, v2
  s_lshl_b32 s42, s44, 3
  v_add_u32 v13, s42, v14
  v_lshlrev_b32 v15, 4, v13
  v_lshl_add_u32 v15, v4, 2, v15
  s_mov_b32 s42, 2752
  v_mul_lo_u32 v7, v15, s42
  v_lshl_add_u32 v7, v5, 4, v7
  s_lshl_b32 s42, s54, 6
  s_cmp_eq_u32 s53, 1
  s_cselect_b32 s22, s26, s24
  s_cselect_b32 s23, s27, s25
  s_mov_b32 s56, s22
  s_and_b32 s57, s23, 0xffff
  s_mov_b32 s58, 1409024
  s_mov_b32 s59, 0x00020000
  v_add_u32 v9, 0, v7
  buffer_load_dwordx4 v[64:67], v9, s[56:59], s42 offen
  v_add_u32 v9, 2752, v7
  buffer_load_dwordx4 v[68:71], v9, s[56:59], s42 offen
  v_add_u32 v9, 5504, v7
  buffer_load_dwordx4 v[72:75], v9, s[56:59], s42 offen
  v_add_u32 v9, 8256, v7
  buffer_load_dwordx4 v[76:79], v9, s[56:59], s42 offen
  v_add_u32 v9, 22016, v7
  buffer_load_dwordx4 v[80:83], v9, s[56:59], s42 offen
  v_add_u32 v9, 24768, v7
  buffer_load_dwordx4 v[84:87], v9, s[56:59], s42 offen
  v_add_u32 v9, 27520, v7
  buffer_load_dwordx4 v[88:91], v9, s[56:59], s42 offen
  v_add_u32 v9, 30272, v7
  buffer_load_dwordx4 v[92:95], v9, s[56:59], s42 offen
  v_lshlrev_b32 v6, 10, v14
  v_lshl_add_u32 v6, v4, 9, v6
  v_lshl_add_u32 v6, v5, 7, v6
  v_add_u32 v6, s45, v6
  v_add_u32 v7, s45, v8
  s_mul_i32 s43, s54, 43691
  s_lshr_b32 s43, s43, 17
  s_mul_i32 s39, s43, 3
  s_sub_u32 s39, s54, s39
  s_lshl_b32 s39, s39, 1
  s_add_u32 s39, s39, s53
  s_lshl_b32 s39, s39, 10
  s_mul_i32 s38, s43, 196608
  s_add_u32 s38, s38, s39
  s_mul_i32 s39, s44, 49152
  s_add_u32 s38, s38, s39
  s_add_u32 s38, s38, 10485760
  s_waitcnt vmcnt(0)
  v_perm_b32 v96, v68, v64, s40
  v_perm_b32 v97, v76, v72, s40
  v_perm_b32 v98, v84, v80, s40
  v_perm_b32 v99, v92, v88, s40
  v_perm_b32 v100, v68, v64, s41
  v_perm_b32 v101, v76, v72, s41
  v_perm_b32 v102, v84, v80, s41
  v_perm_b32 v103, v92, v88, s41
  v_perm_b32 v104, v69, v65, s40
  v_perm_b32 v105, v77, v73, s40
  v_perm_b32 v106, v85, v81, s40
  v_perm_b32 v107, v93, v89, s40
  v_perm_b32 v108, v69, v65, s41
  v_perm_b32 v109, v77, v73, s41
  v_perm_b32 v110, v85, v81, s41
  v_perm_b32 v111, v93, v89, s41
  v_perm_b32 v112, v70, v66, s40
  v_perm_b32 v113, v78, v74, s40
  v_perm_b32 v114, v86, v82, s40
  v_perm_b32 v115, v94, v90, s40
  v_perm_b32 v116, v70, v66, s41
  v_perm_b32 v117, v78, v74, s41
  v_perm_b32 v118, v86, v82, s41
  v_perm_b32 v119, v94, v90, s41
  v_perm_b32 v120, v71, v67, s40
  v_perm_b32 v121, v79, v75, s40
  v_perm_b32 v122, v87, v83, s40
  v_perm_b32 v123, v95, v91, s40
  v_perm_b32 v124, v71, v67, s41
  v_perm_b32 v125, v79, v75, s41
  v_perm_b32 v126, v87, v83, s41
  v_perm_b32 v127, v95, v91, s41
  ds_write_b128 v6, v[96:99] offset:0
  ds_write_b128 v6, v[100:103] offset:16
  ds_write_b128 v6, v[104:107] offset:32
  ds_write_b128 v6, v[108:111] offset:48
  ds_write_b128 v6, v[112:115] offset:64
  ds_write_b128 v6, v[116:119] offset:80
  ds_write_b128 v6, v[120:123] offset:96
  ds_write_b128 v6, v[124:127] offset:112
  s_waitcnt lgkmcnt(0)
  ds_read_b128 v[96:99], v7 offset:0
  ds_read_b128 v[100:103], v7 offset:1024
  ds_read_b128 v[104:107], v7 offset:2048
  ds_read_b128 v[108:111], v7 offset:3072
  ds_read_b128 v[112:115], v7 offset:4096
  ds_read_b128 v[116:119], v7 offset:5120
  ds_read_b128 v[120:123], v7 offset:6144
  ds_read_b128 v[124:127], v7 offset:7168
  s_waitcnt lgkmcnt(0)
  buffer_store_dwordx4 v[96:99], v8, s[8:11], s38 offen sc1
  s_add_u32 s38, s38, 6144
  buffer_store_dwordx4 v[100:103], v8, s[8:11], s38 offen sc1
  s_add_u32 s38, s38, 6144
  buffer_store_dwordx4 v[104:107], v8, s[8:11], s38 offen sc1
  s_add_u32 s38, s38, 6144
  buffer_store_dwordx4 v[108:111], v8, s[8:11], s38 offen sc1
  s_add_u32 s38, s38, 6144
  buffer_store_dwordx4 v[112:115], v8, s[8:11], s38 offen sc1
  s_add_u32 s38, s38, 6144
  buffer_store_dwordx4 v[116:119], v8, s[8:11], s38 offen sc1
  s_add_u32 s38, s38, 6144
  buffer_store_dwordx4 v[120:123], v8, s[8:11], s38 offen sc1
  s_add_u32 s38, s38, 6144
  buffer_store_dwordx4 v[124:127], v8, s[8:11], s38 offen sc1
  s_add_u32 s38, s38, 6144
  s_lshl_b32 s55, s43, 8
  s_add_u32 s55, s55, 245760
  s_branch RL_END
RL_W2:
  s_mov_b32 s56, s28
  s_and_b32 s57, s29, 0xffff
  s_mov_b32 s58, 1409024
  s_mov_b32 s59, 0x00020000
  s_sub_u32 s53, s52, 344
RL_W2L:
  s_and_b32 s35, s53, 7
  s_lshr_b32 s34, s53, 3
  v_lshrrev_b32 v3, 4, v2
  v_bfe_u32 v12, v2, 3, 1
  v_and_b32 v4, 7, v2
  v_lshlrev_b32 v5, 14, v3
  v_lshl_add_u32 v5, v12, 12, v5
  v_lshl_add_u32 v5, v4, 4, v5
  v_add_u32 v9, 8192, v5
  s_lshl_b32 s36, s34, 16
  s_lshl_b32 s37, s35, 7
  s_add_u32 s36, s36, s37
  buffer_load_dwordx4 v[64:67], v5, s[56:59], s36 offen offset:0
  buffer_load_dwordx4 v[68:71], v5, s[56:59], s36 offen offset:1024
  buffer_load_dwordx4 v[72:75], v5, s[56:59], s36 offen offset:2048
  buffer_load_dwordx4 v[76:79], v5, s[56:59], s36 offen offset:3072
  buffer_load_dwordx4 v[80:83], v9, s[56:59], s36 offen offset:0
  buffer_load_dwordx4 v[84:87], v9, s[56:59], s36 offen offset:1024
  buffer_load_dwordx4 v[88:91], v9, s[56:59], s36 offen offset:2048
  buffer_load_dwordx4 v[92:95], v9, s[56:59], s36 offen offset:3072
  v_lshrrev_b32 v6, 2, v4
  v_lshl_add_u32 v6, v6, 2, v3
  v_lshlrev_b32 v6, 10, v6
  v_lshl_add_u32 v6, v12, 9, v6
  v_and_b32 v7, 3, v4
  v_lshl_add_u32 v6, v7, 7, v6
  s_mov_b32 s42, s45
  v_add_u32 v6, s42, v6
  v_add_u32 v7, s42, v8
  s_mul_i32 s36, s35, 176128
  s_lshl_b32 s37, s34, 12
  s_add_u32 s36, s36, s37
  s_add_u32 s36, s36, 19922944
  s_add_u32 s37, s36, 88064
  s_cmp_eq_u32 s34, 21
  s_cselect_b32 s42, 0x7ff00000, 0
  v_add_u32 v9, s42, v8
  s_waitcnt vmcnt(0)
  v_perm_b32 v96, v68, v64, s40
  v_perm_b32 v97, v76, v72, s40
  v_perm_b32 v98, v84, v80, s40
  v_perm_b32 v99, v92, v88, s40
  v_perm_b32 v100, v68, v64, s41
  v_perm_b32 v101, v76, v72, s41
  v_perm_b32 v102, v84, v80, s41
  v_perm_b32 v103, v92, v88, s41
  v_perm_b32 v104, v69, v65, s40
  v_perm_b32 v105, v77, v73, s40
  v_perm_b32 v106, v85, v81, s40
  v_perm_b32 v107, v93, v89, s40
  v_perm_b32 v108, v69, v65, s41
  v_perm_b32 v109, v77, v73, s41
  v_perm_b32 v110, v85, v81, s41
  v_perm_b32 v111, v93, v89, s41
  v_perm_b32 v112, v70, v66, s40
  v_perm_b32 v113, v78, v74, s40
  v_perm_b32 v114, v86, v82, s40
  v_perm_b32 v115, v94, v90, s40
  v_perm_b32 v116, v70, v66, s41
  v_perm_b32 v117, v78, v74, s41
  v_perm_b32 v118, v86, v82, s41
  v_perm_b32 v119, v94, v90, s41
  v_perm_b32 v120, v71, v67, s40
  v_perm_b32 v121, v79, v75, s40
  v_perm_b32 v122, v87, v83, s40
  v_perm_b32 v123, v95, v91, s40
  v_perm_b32 v124, v71, v67, s41
  v_perm_b32 v125, v79, v75, s41
  v_perm_b32 v126, v87, v83, s41
  v_perm_b32 v127, v95, v91, s41
  ds_write_b128 v6, v[96:99] offset:0
  ds_write_b128 v6, v[100:103] offset:16
  ds_write_b128 v6, v[104:107] offset:32
  ds_write_b128 v6, v[108:111] offset:48
  ds_write_b128 v6, v[112:115] offset:64
  ds_write_b128 v6, v[116:119] offset:80
  ds_write_b128 v6, v[120:123] offset:96
  ds_write_b128 v6, v[124:127] offset:112
  s_waitcnt lgkmcnt(0)
  ds_read_b128 v[96:99], v7 offset:0
  ds_read_b128 v[100:103], v7 offset:1024
  ds_read_b128 v[104:107], v7 offset:2048
  ds_read_b128 v[108:111], v7 offset:3072
  ds_read_b128 v[112:115], v7 offset:4096
  ds_read_b128 v[116:119], v7 offset:5120
  ds_read_b128 v[120:123], v7 offset:6144
  ds_read_b128 v[124:127], v7 offset:7168
  s_waitcnt lgkmcnt(0)
  buffer_store_dwordx4 v[96:99], v8, s[8:11], s36 offen offset:0 sc1
  buffer_store_dwordx4 v[100:103], v8, s[8:11], s36 offen offset:1024 sc1
  buffer_store_dwordx4 v[104:107], v9, s[8:11], s36 offen offset:2048 sc1
  buffer_store_dwordx4 v[108:111], v9, s[8:11], s36 offen offset:3072 sc1
  buffer_store_dwordx4 v[112:115], v8, s[8:11], s37 offen offset:0 sc1
  buffer_store_dwordx4 v[116:119], v8, s[8:11], s37 offen offset:1024 sc1
  buffer_store_dwordx4 v[120:123], v9, s[8:11], s37 offen offset:2048 sc1
  buffer_store_dwordx4 v[124:127], v9, s[8:11], s37 offen offset:3072 sc1
  s_lshl_b32 s55, s35, 8
  s_add_u32 s55, s55, 249856
  s_cmp_ge_u32 s53, 8
  s_cbranch_scc1 RL_END
  s_waitcnt vmcnt(0)
  v_mov_b32 v0, 0
  v_mov_b32 v1, 1
  s_mov_b64 exec, 1
  buffer_atomic_add v1, v0, s[8:11], s55 offen sc1
  s_mov_b64 exec, -1
  s_add_u32 s53, s53, 168
  s_branch RL_W2L
RL_END:
  s_bfe_u32 s33, s2, 0x20001
  s_lshl_b32 s33, s33, 3
  s_bfe_u32 s34, s2, 0x30003
  s_add_u32 s33, s33, s34
  s_and_b32 s34, s2, 1
  s_lshl_b32 s34, s34, 2
  s_lshr_b32 s35, s2, 6
  s_add_u32 s34, s34, s35
  s_and_b32 s51, s3, 1
  s_cmp_ge_u32 s50, 2
  s_cbranch_scc1 L2_A
  s_lshl_b32 s36, s33, 1
  s_add_u32 s36, s36, s51
  s_lshl_b32 s38, s36, 15
  s_add_u32 s38, s38, 5242880
  s_lshl_b32 s40, s51, 15
  s_add_u32 s40, s40, 65536
  s_lshl_b32 s43, s36, 8
  s_add_u32 s43, s43, 196608
  s_waitcnt vmcnt(0)
  v_mov_b32 v0, 0
  v_mov_b32 v1, 1
  s_mov_b64 exec, 1
  buffer_atomic_add v1, v0, s[8:11], s55 offen sc1
  s_mov_b64 exec, -1
  v_mov_b32 v0, 0
  s_mov_b32 s31, 0
L_PL2:
  buffer_load_dword v1, v0, s[8:11], s43 offen sc1
  s_waitcnt vmcnt(0)
  v_readfirstlane_b32 s30, v1
  s_add_u32 s31, s31, 1
  s_cmp_ge_u32 s30, 16
  s_cbranch_scc1 L_PL2_OK
  s_cmp_ge_u32 s31, 0x100000
  s_cbranch_scc1 L_PL2_OK
  s_sleep 1
  s_branch L_PL2
L_PL2_OK:
  s_mov_b32 m0, s40
  s_nop 0
  buffer_load_dwordx4 v8, s[8:11], s38 offen offset:0 sc1 lds
  buffer_load_dwordx4 v8, s[8:11], s38 offen offset:1024 sc1 lds
  buffer_load_dwordx4 v8, s[8:11], s38 offen offset:2048 sc1 lds
  buffer_load_dwordx4 v8, s[8:11], s38 offen offset:3072 sc1 lds
  s_add_u32 s38, s38, 4096
  s_add_u32 s40, s40, 4096
  s_mov_b32 m0, s40
  s_nop 0
  buffer_load_dwordx4 v8, s[8:11], s38 offen offset:0 sc1 lds
  buffer_load_dwordx4 v8, s[8:11], s38 offen offset:1024 sc1 lds
  buffer_load_dwordx4 v8, s[8:11], s38 offen offset:2048 sc1 lds
  buffer_load_dwordx4 v8, s[8:11], s38 offen offset:3072 sc1 lds
  s_add_u32 s38, s38, 4096
  s_add_u32 s40, s40, 4096
  s_mov_b32 m0, s40
  s_nop 0
  buffer_load_dwordx4 v8, s[8:11], s38 offen offset:0 sc1 lds
  buffer_load_dwordx4 v8, s[8:11], s38 offen offset:1024 sc1 lds
  buffer_load_dwordx4 v8, s[8:11], s38 offen offset:2048 sc1 lds
  buffer_load_dwordx4 v8, s[8:11], s38 offen offset:3072 sc1 lds
  s_add_u32 s38, s38, 4096
  s_add_u32 s40, s40, 4096
  s_mov_b32 m0, s40
  s_nop 0
  buffer_load_dwordx4 v8, s[8:11], s38 offen offset:0 sc1 lds
  buffer_load_dwordx4 v8, s[8:11], s38 offen offset:1024 sc1 lds
  buffer_load_dwordx4 v8, s[8:11], s38 offen offset:2048 sc1 lds
  buffer_load_dwordx4 v8, s[8:11], s38 offen offset:3072 sc1 lds
  s_add_u32 s38, s38, 4096
  s_add_u32 s40, s40, 4096
  s_mov_b32 m0, s40
  s_nop 0
  buffer_load_dwordx4 v8, s[8:11], s38 offen offset:0 sc1 lds
  buffer_load_dwordx4 v8, s[8:11], s38 offen offset:1024 sc1 lds
  buffer_load_dwordx4 v8, s[8:11], s38 offen offset:2048 sc1 lds
  buffer_load_dwordx4 v8, s[8:11], s38 offen offset:3072 sc1 lds
  s_add_u32 s38, s38, 4096
  s_add_u32 s40, s40, 4096
  s_mov_b32 m0, s40
  s_nop 0
  buffer_load_dwordx4 v8, s[8:11], s38 offen offset:0 sc1 lds
  buffer_load_dwordx4 v8, s[8:11], s38 offen offset:1024 sc1 lds
  buffer_load_dwordx4 v8, s[8:11], s38 offen offset:2048 sc1 lds
  buffer_load_dwordx4 v8, s[8:11], s38 offen offset:3072 sc1 lds
  s_add_u32 s38, s38, 4096
  s_add_u32 s40, s40, 4096
  s_mov_b32 m0, s40
  s_nop 0
  buffer_load_dwordx4 v8, s[8:11], s38 offen offset:0 sc1 lds
  buffer_load_dwordx4 v8, s[8:11], s38 offen offset:1024 sc1 lds
  buffer_load_dwordx4 v8, s[8:11], s38 offen offset:2048 sc1 lds
  buffer_load_dwordx4 v8, s[8:11], s38 offen offset:3072 sc1 lds
  s_add_u32 s38, s38, 4096
  s_add_u32 s40, s40, 4096
  s_mov_b32 m0, s40
  s_nop 0
  buffer_load_dwordx4 v8, s[8:11], s38 offen offset:0 sc1 lds
  buffer_load_dwordx4 v8, s[8:11], s38 offen offset:1024 sc1 lds
  buffer_load_dwordx4 v8, s[8:11], s38 offen offset:2048 sc1 lds
  buffer_load_dwordx4 v8, s[8:11], s38 offen offset:3072 sc1 lds
  s_add_u32 s38, s38, 4096
  s_add_u32 s40, s40, 4096
  s_waitcnt vmcnt(24)
  s_barrier
  s_waitcnt vmcnt(16)
  s_barrier
  s_waitcnt vmcnt(8)
  s_barrier
  s_waitcnt vmcnt(0)
  s_barrier
  s_branch L2_E
L2_A:
  s_lshl_b32 s38, s34, 1
  s_add_u32 s38, s38, s51
  s_lshl_b32 s38, s38, 15
  s_add_u32 s38, s38, 7340032
  s_lshl_b32 s40, s51, 15
  s_mov_b32 m0, s40
  s_nop 0
  buffer_load_dwordx4 v8, s[8:11], s38 offen offset:0 lds
  buffer_load_dwordx4 v8, s[8:11], s38 offen offset:1024 lds
  buffer_load_dwordx4 v8, s[8:11], s38 offen offset:2048 lds
  buffer_load_dwordx4 v8, s[8:11], s38 offen offset:3072 lds
  s_add_u32 s38, s38, 4096
  s_add_u32 s40, s40, 4096
  s_mov_b32 m0, s40
  s_nop 0
  buffer_load_dwordx4 v8, s[8:11], s38 offen offset:0 lds
  buffer_load_dwordx4 v8, s[8:11], s38 offen offset:1024 lds
  buffer_load_dwordx4 v8, s[8:11], s38 offen offset:2048 lds
  buffer_load_dwordx4 v8, s[8:11], s38 offen offset:3072 lds
  s_add_u32 s38, s38, 4096
  s_add_u32 s40, s40, 4096
  s_mov_b32 m0, s40
  s_nop 0
  buffer_load_dwordx4 v8, s[8:11], s38 offen offset:0 lds
  buffer_load_dwordx4 v8, s[8:11], s38 offen offset:1024 lds
  buffer_load_dwordx4 v8, s[8:11], s38 offen offset:2048 lds
  buffer_load_dwordx4 v8, s[8:11], s38 offen offset:3072 lds
  s_add_u32 s38, s38, 4096
  s_add_u32 s40, s40, 4096
  s_mov_b32 m0, s40
  s_nop 0
  buffer_load_dwordx4 v8, s[8:11], s38 offen offset:0 lds
  buffer_load_dwordx4 v8, s[8:11], s38 offen offset:1024 lds
  buffer_load_dwordx4 v8, s[8:11], s38 offen offset:2048 lds
  buffer_load_dwordx4 v8, s[8:11], s38 offen offset:3072 lds
  s_add_u32 s38, s38, 4096
  s_add_u32 s40, s40, 4096
  s_mov_b32 m0, s40
  s_nop 0
  buffer_load_dwordx4 v8, s[8:11], s38 offen offset:0 lds
  buffer_load_dwordx4 v8, s[8:11], s38 offen offset:1024 lds
  buffer_load_dwordx4 v8, s[8:11], s38 offen offset:2048 lds
  buffer_load_dwordx4 v8, s[8:11], s38 offen offset:3072 lds
  s_add_u32 s38, s38, 4096
  s_add_u32 s40, s40, 4096
  s_mov_b32 m0, s40
  s_nop 0
  buffer_load_dwordx4 v8, s[8:11], s38 offen offset:0 lds
  buffer_load_dwordx4 v8, s[8:11], s38 offen offset:1024 lds
  buffer_load_dwordx4 v8, s[8:11], s38 offen offset:2048 lds
  buffer_load_dwordx4 v8, s[8:11], s38 offen offset:3072 lds
  s_add_u32 s38, s38, 4096
  s_add_u32 s40, s40, 4096
  s_mov_b32 m0, s40
  s_nop 0
  buffer_load_dwordx4 v8, s[8:11], s38 offen offset:0 lds
  buffer_load_dwordx4 v8, s[8:11], s38 offen offset:1024 lds
  buffer_load_dwordx4 v8, s[8:11], s38 offen offset:2048 lds
  buffer_load_dwordx4 v8, s[8:11], s38 offen offset:3072 lds
  s_add_u32 s38, s38, 4096
  s_add_u32 s40, s40, 4096
  s_mov_b32 m0, s40
  s_nop 0
  buffer_load_dwordx4 v8, s[8:11], s38 offen offset:0 lds
  buffer_load_dwordx4 v8, s[8:11], s38 offen offset:1024 lds
  buffer_load_dwordx4 v8, s[8:11], s38 offen offset:2048 lds
  buffer_load_dwordx4 v8, s[8:11], s38 offen offset:3072 lds
  s_add_u32 s38, s38, 4096
  s_add_u32 s40, s40, 4096
  s_waitcnt vmcnt(0)
  s_barrier
  s_barrier
  s_barrier
  s_barrier
L2_E:
  s_barrier
  s_bfe_u32 s33, s2, 0x10002
  s_lshl_b32 s33, s33, 3
  s_bfe_u32 s34, s2, 0x30003
  s_add_u32 s33, s33, s34
  s_and_b32 s34, s2, 3
  s_lshl_b32 s34, s34, 2
  s_lshr_b32 s35, s2, 6
  s_add_u32 s34, s34, s35
  s_cmp_ge_u32 s34, 15
  s_cbranch_scc1 UT_GO
  s_mul_i32 s38, s34, 196608
  s_add_u32 s38, s38, 10485760
  s_mul_i32 s39, s50, 3072
  s_add_u32 s38, s38, s39
  s_mov_b32 s40, s39
  s_mul_i32 s42, s34, 384
  s_add_u32 s42, s42, 81920
  s_lshl_b32 s45, s34, 8
  s_add_u32 s45, s45, 253952
  s_cmp_eq_u32 s34, 14
  s_cselect_b32 s46, 2, 6
  s_lshl_b32 s43, s34, 8
  s_add_u32 s43, s43, 245760
  s_lshl_b32 s44, s46, 2
  v_mov_b32 v0, 0
  s_mov_b32 s31, 0
L_PLW:
  buffer_load_dword v1, v0, s[8:11], s43 offen sc1
  s_waitcnt vmcnt(0)
  v_readfirstlane_b32 s30, v1
  s_add_u32 s31, s31, 1
  s_cmp_ge_u32 s30, s44
  s_cbranch_scc1 L_PLW_OK
  s_cmp_ge_u32 s31, 0x100000
  s_cbranch_scc1 L_PLW_OK
  s_sleep 1
  s_branch L_PLW
L_PLW_OK:
  s_mov_b32 m0, s40
  s_nop 0
  buffer_load_dwordx4 v8, s[8:11], s38 offen offset:0 sc1 lds
  buffer_load_dwordx4 v8, s[8:11], s38 offen offset:1024 sc1 lds
  buffer_load_dwordx4 v8, s[8:11], s38 offen offset:2048 sc1 lds
  s_add_u32 s38, s38, 12288
  s_add_u32 s40, s40, 12288
  s_mov_b32 m0, s40
  s_nop 0
  buffer_load_dwordx4 v8, s[8:11], s38 offen offset:0 sc1 lds
  buffer_load_dwordx4 v8, s[8:11], s38 offen offset:1024 sc1 lds
  buffer_load_dwordx4 v8, s[8:11], s38 offen offset:2048 sc1 lds
  s_add_u32 s38, s38, 12288
  s_add_u32 s40, s40, 12288
  s_mov_b32 m0, s40
  s_nop 0
  buffer_load_dwordx4 v8, s[8:11], s38 offen offset:0 sc1 lds
  buffer_load_dwordx4 v8, s[8:11], s38 offen offset:1024 sc1 lds
  buffer_load_dwordx4 v8, s[8:11], s38 offen offset:2048 sc1 lds
  s_add_u32 s38, s38, 12288
  s_add_u32 s40, s40, 12288
  s_mov_b32 m0, s40
  s_nop 0
  buffer_load_dwordx4 v8, s[8:11], s38 offen offset:0 sc1 lds
  buffer_load_dwordx4 v8, s[8:11], s38 offen offset:1024 sc1 lds
  buffer_load_dwordx4 v8, s[8:11], s38 offen offset:2048 sc1 lds
  s_add_u32 s38, s38, 12288
  s_add_u32 s40, s40, 12288
  s_mov_b32 m0, s40
  s_nop 0
  buffer_load_dwordx4 v8, s[8:11], s38 offen offset:0 sc1 lds
  buffer_load_dwordx4 v8, s[8:11], s38 offen offset:1024 sc1 lds
  buffer_load_dwordx4 v8, s[8:11], s38 offen offset:2048 sc1 lds
  s_add_u32 s38, s38, 12288
  s_add_u32 s40, s40, 12288
  s_mov_b32 m0, s40
  s_nop 0
  buffer_load_dwordx4 v8, s[8:11], s38 offen offset:0 sc1 lds
  buffer_load_dwordx4 v8, s[8:11], s38 offen offset:1024 sc1 lds
  buffer_load_dwordx4 v8, s[8:11], s38 offen offset:2048 sc1 lds
  s_add_u32 s38, s38, 12288
  s_add_u32 s40, s40, 12288
  s_mov_b32 m0, s40
  s_nop 0
  buffer_load_dwordx4 v8, s[8:11], s38 offen offset:0 sc1 lds
  buffer_load_dwordx4 v8, s[8:11], s38 offen offset:1024 sc1 lds
  buffer_load_dwordx4 v8, s[8:11], s38 offen offset:2048 sc1 lds
  s_add_u32 s38, s38, 12288
  s_add_u32 s40, s40, 12288
  s_mov_b32 m0, s40
  s_nop 0
  buffer_load_dwordx4 v8, s[8:11], s38 offen offset:0 sc1 lds
  buffer_load_dwordx4 v8, s[8:11], s38 offen offset:1024 sc1 lds
  buffer_load_dwordx4 v8, s[8:11], s38 offen offset:2048 sc1 lds
  s_add_u32 s38, s38, 12288
  s_add_u32 s40, s40, 12288
  s_mov_b32 m0, s40
  s_nop 0
  buffer_load_dwordx4 v8, s[8:11], s38 offen offset:0 sc1 lds
  buffer_load_dwordx4 v8, s[8:11], s38 offen offset:1024 sc1 lds
  buffer_load_dwordx4 v8, s[8:11], s38 offen offset:2048 sc1 lds
  s_add_u32 s38, s38, 12288
  s_add_u32 s40, s40, 12288
  s_mov_b32 m0, s40
  s_nop 0
  buffer_load_dwordx4 v8, s[8:11], s38 offen offset:0 sc1 lds
  buffer_load_dwordx4 v8, s[8:11], s38 offen offset:1024 sc1 lds
  buffer_load_dwordx4 v8, s[8:11], s38 offen offset:2048 sc1 lds
  s_add_u32 s38, s38, 12288
  s_add_u32 s40, s40, 12288
  s_mov_b32 m0, s40
  s_nop 0
  buffer_load_dwordx4 v8, s[8:11], s38 offen offset:0 sc1 lds
  buffer_load_dwordx4 v8, s[8:11], s38 offen offset:1024 sc1 lds
  buffer_load_dwordx4 v8, s[8:11], s38 offen offset:2048 sc1 lds
  s_add_u32 s38, s38, 12288
  s_add_u32 s40, s40, 12288
  s_mov_b32 m0, s40
  s_nop 0
  buffer_load_dwordx4 v8, s[8:11], s38 offen offset:0 sc1 lds
  buffer_load_dwordx4 v8, s[8:11], s38 offen offset:1024 sc1 lds
  buffer_load_dwordx4 v8, s[8:11], s38 offen offset:2048 sc1 lds
  s_add_u32 s38, s38, 12288
  s_add_u32 s40, s40, 12288
  s_waitcnt vmcnt(33)
  s_barrier
  s_waitcnt vmcnt(30)
  s_barrier
  s_waitcnt vmcnt(27)
  s_barrier
  s_mov_b32 s40, s39
  s_mov_b32 m0, s40
  s_nop 0
  buffer_load_dwordx4 v8, s[8:11], s38 offen offset:0 sc1 lds
  buffer_load_dwordx4 v8, s[8:11], s38 offen offset:1024 sc1 lds
  buffer_load_dwordx4 v8, s[8:11], s38 offen offset:2048 sc1 lds
  s_add_u32 s38, s38, 12288
  s_add_u32 s40, s40, 12288
  s_waitcnt vmcnt(27)
  s_barrier
  s_mov_b32 m0, s40
  s_nop 0
  buffer_load_dwordx4 v8, s[8:11], s38 offen offset:0 sc1 lds
  buffer_load_dwordx4 v8, s[8:11], s38 offen offset:1024 sc1 lds
  buffer_load_dwordx4 v8, s[8:11], s38 offen offset:2048 sc1 lds
  s_add_u32 s38, s38, 12288
  s_add_u32 s40, s40, 12288
  s_waitcnt vmcnt(27)
  s_barrier
  s_mov_b32 m0, s40
  s_nop 0
  buffer_load_dwordx4 v8, s[8:11], s38 offen offset:0 sc1 lds
  buffer_load_dwordx4 v8, s[8:11], s38 offen offset:1024 sc1 lds
  buffer_load_dwordx4 v8, s[8:11], s38 offen offset:2048 sc1 lds
  s_add_u32 s38, s38, 12288
  s_add_u32 s40, s40, 12288
  s_waitcnt vmcnt(27)
  s_barrier
  s_mov_b32 m0, s40
  s_nop 0
  buffer_load_dwordx4 v8, s[8:11], s38 offen offset:0 sc1 lds
  buffer_load_dwordx4 v8, s[8:11], s38 offen offset:1024 sc1 lds
  buffer_load_dwordx4 v8, s[8:11], s38 offen offset:2048 sc1 lds
  s_add_u32 s38, s38, 12288
  s_add_u32 s40, s40, 12288
  s_waitcnt vmcnt(27)
  s_barrier
  s_waitcnt vmcnt(24)
  s_barrier
  s_waitcnt vmcnt(21)
  s_barrier
  s_waitcnt vmcnt(18)
  s_barrier
  s_waitcnt vmcnt(15)
  s_barrier
  s_waitcnt vmcnt(12)
  s_barrier
  s_waitcnt vmcnt(9)
  s_barrier
  s_waitcnt vmcnt(6)
  s_barrier
  s_cmp_lg_u32 s50, 0
  s_cbranch_scc1 L_NOU
  v_mov_b32 v0, 0
  s_mov_b32 s31, 0
L_PLU:
  buffer_load_dword v1, v0, s[8:11], s45 offen sc1
  s_waitcnt vmcnt(0)
  v_readfirstlane_b32 s30, v1
  s_add_u32 s31, s31, 1
  s_cmp_ge_u32 s30, s46
  s_cbranch_scc1 L_PLU_OK
  s_cmp_ge_u32 s31, 0x100000
  s_cbranch_scc1 L_PLU_OK
  s_sleep 1
  s_branch L_PLU
L_PLU_OK:
  s_mov_b64 exec, 0xffffff
  s_mov_b32 m0, 147456
  s_add_u32 s43, s42, 0
  buffer_load_dwordx4 v8, s[8:11], s43 offen sc1 lds
  s_mov_b32 m0, 147840
  s_add_u32 s43, s42, 5632
  buffer_load_dwordx4 v8, s[8:11], s43 offen sc1 lds
  s_mov_b32 m0, 148224
  s_add_u32 s43, s42, 11264
  buffer_load_dwordx4 v8, s[8:11], s43 offen sc1 lds
  s_mov_b32 m0, 148608
  s_add_u32 s43, s42, 16896
  buffer_load_dwordx4 v8, s[8:11], s43 offen sc1 lds
  s_mov_b64 exec, -1
L_NOU:
  s_waitcnt vmcnt(3)
  s_barrier
  s_waitcnt vmcnt(0)
  s_barrier
  s_barrier
  s_waitcnt vmcnt(0)
  s_barrier
L_P4:
  s_bfe_u32 s33, s2, 0x20001
  s_lshl_b32 s33, s33, 3
  s_bfe_u32 s34, s2, 0x30003
  s_add_u32 s33, s33, s34
  s_and_b32 s34, s2, 1
  s_lshl_b32 s34, s34, 2
  s_lshr_b32 s35, s2, 6
  s_add_u32 s34, s34, s35
  s_and_b32 s51, s3, 1
  s_lshl_b32 s36, s33, 1
  s_add_u32 s36, s36, s51
  s_mul_i32 s37, s36, 88064
  s_add_u32 s37, s37, 13631488
  s_lshl_b32 s38, s34, 1
  s_add_u32 s38, s38, s51
  s_mul_i32 s38, s38, 88064
  s_add_u32 s38, s38, 19922944
  s_lshl_b32 s39, s50, 13
  s_mov_b32 s40, s39
  s_lshl_b32 s43, s34, 8
  s_add_u32 s43, s43, 249856
  s_mov_b32 s44, 22
  s_cmp_ge_u32 s50, 2
  s_cbranch_scc1 L4_PL
  s_mov_b32 s38, s37
  s_lshl_b32 s43, s36, 8
  s_add_u32 s43, s43, 229376
  s_mov_b32 s44, 15
L4_PL:
  v_mov_b32 v0, 0
  s_mov_b32 s31, 0
L_PL4:
  buffer_load_dword v1, v0, s[8:11], s43 offen sc1
  s_waitcnt vmcnt(0)
  v_readfirstlane_b32 s30, v1
  s_add_u32 s31, s31, 1
  s_cmp_ge_u32 s30, s44
  s_cbranch_scc1 L_PL4_OK
  s_cmp_ge_u32 s31, 0x100000
  s_cbranch_scc1 L_PL4_OK
  s_sleep 1
  s_branch L_PL4
L_PL4_OK:
L4_GO:
  s_add_u32 m0, s40, 0
  s_nop 0
  buffer_load_dwordx4 v8, s[8:11], s38 offen offset:0 sc1 lds
  buffer_load_dwordx4 v8, s[8:11], s38 offen offset:1024 sc1 lds
  buffer_load_dwordx4 v8, s[8:11], s38 offen offset:2048 sc1 lds
  buffer_load_dwordx4 v8, s[8:11], s38 offen offset:3072 sc1 lds
  s_add_u32 s38, s38, 4096
  s_add_u32 m0, s40, 4096
  s_nop 0
  buffer_load_dwordx4 v8, s[8:11], s38 offen offset:0 sc1 lds
  buffer_load_dwordx4 v8, s[8:11], s38 offen offset:1024 sc1 lds
  buffer_load_dwordx4 v8, s[8:11], s38 offen offset:2048 sc1 lds
  buffer_load_dwordx4 v8, s[8:11], s38 offen offset:3072 sc1 lds
  s_add_u32 s38, s38, 4096
  s_add_u32 s40, s40, 32768
  s_add_u32 m0, s40, 0
  s_nop 0
  buffer_load_dwordx4 v8, s[8:11], s38 offen offset:0 sc1 lds
  buffer_load_dwordx4 v8, s[8:11], s38 offen offset:1024 sc1 lds
  buffer_load_dwordx4 v8, s[8:11], s38 offen offset:2048 sc1 lds
  buffer_load_dwordx4 v8, s[8:11], s38 offen offset:3072 sc1 lds
  s_add_u32 s38, s38, 4096
  s_add_u32 m0, s40, 4096
  s_nop 0
  buffer_load_dwordx4 v8, s[8:11], s38 offen offset:0 sc1 lds
  buffer_load_dwordx4 v8, s[8:11], s38 offen offset:1024 sc1 lds
  buffer_load_dwordx4 v8, s[8:11], s38 offen offset:2048 sc1 lds
  buffer_load_dwordx4 v8, s[8:11], s38 offen offset:3072 sc1 lds
  s_add_u32 s38, s38, 4096
  s_add_u32 s40, s40, 32768
  s_add_u32 m0, s40, 0
  s_nop 0
  buffer_load_dwordx4 v8, s[8:11], s38 offen offset:0 sc1 lds
  buffer_load_dwordx4 v8, s[8:11], s38 offen offset:1024 sc1 lds
  buffer_load_dwordx4 v8, s[8:11], s38 offen offset:2048 sc1 lds
  buffer_load_dwordx4 v8, s[8:11], s38 offen offset:3072 sc1 lds
  s_add_u32 s38, s38, 4096
  s_add_u32 m0, s40, 4096
  s_nop 0
  buffer_load_dwordx4 v8, s[8:11], s38 offen offset:0 sc1 lds
  buffer_load_dwordx4 v8, s[8:11], s38 offen offset:1024 sc1 lds
  buffer_load_dwordx4 v8, s[8:11], s38 offen offset:2048 sc1 lds
  buffer_load_dwordx4 v8, s[8:11], s38 offen offset:3072 sc1 lds
  s_add_u32 s38, s38, 4096
  s_add_u32 s40, s40, 32768
  s_add_u32 m0, s40, 0
  s_nop 0
  buffer_load_dwordx4 v8, s[8:11], s38 offen offset:0 sc1 lds
  buffer_load_dwordx4 v8, s[8:11], s38 offen offset:1024 sc1 lds
  buffer_load_dwordx4 v8, s[8:11], s38 offen offset:2048 sc1 lds
  buffer_load_dwordx4 v8, s[8:11], s38 offen offset:3072 sc1 lds
  s_add_u32 s38, s38, 4096
  s_add_u32 m0, s40, 4096
  s_nop 0
  buffer_load_dwordx4 v8, s[8:11], s38 offen offset:0 sc1 lds
  buffer_load_dwordx4 v8, s[8:11], s38 offen offset:1024 sc1 lds
  buffer_load_dwordx4 v8, s[8:11], s38 offen offset:2048 sc1 lds
  buffer_load_dwordx4 v8, s[8:11], s38 offen offset:3072 sc1 lds
  s_add_u32 s38, s38, 4096
  s_add_u32 s40, s40, 32768
  s_waitcnt vmcnt(24)
  s_barrier
  s_waitcnt vmcnt(16)
  s_barrier
  s_waitcnt vmcnt(8)
  s_barrier
  s_mov_b32 s40, s39
  s_add_u32 m0, s40, 0
  s_nop 0
  buffer_load_dwordx4 v8, s[8:11], s38 offen offset:0 sc1 lds
  buffer_load_dwordx4 v8, s[8:11], s38 offen offset:1024 sc1 lds
  buffer_load_dwordx4 v8, s[8:11], s38 offen offset:2048 sc1 lds
  buffer_load_dwordx4 v8, s[8:11], s38 offen offset:3072 sc1 lds
  s_add_u32 s38, s38, 4096
  s_add_u32 m0, s40, 4096
  s_nop 0
  buffer_load_dwordx4 v8, s[8:11], s38 offen offset:0 sc1 lds
  buffer_load_dwordx4 v8, s[8:11], s38 offen offset:1024 sc1 lds
  buffer_load_dwordx4 v8, s[8:11], s38 offen offset:2048 sc1 lds
  buffer_load_dwordx4 v8, s[8:11], s38 offen offset:3072 sc1 lds
  s_add_u32 s38, s38, 4096
  s_add_u32 s40, s40, 32768
  s_waitcnt vmcnt(8)
  s_barrier
  s_add_u32 m0, s40, 0
  s_nop 0
  buffer_load_dwordx4 v8, s[8:11], s38 offen offset:0 sc1 lds
  buffer_load_dwordx4 v8, s[8:11], s38 offen offset:1024 sc1 lds
  buffer_load_dwordx4 v8, s[8:11], s38 offen offset:2048 sc1 lds
  buffer_load_dwordx4 v8, s[8:11], s38 offen offset:3072 sc1 lds
  s_add_u32 s38, s38, 4096
  s_add_u32 m0, s40, 4096
  s_nop 0
  buffer_load_dwordx4 v8, s[8:11], s38 offen offset:0 sc1 lds
  buffer_load_dwordx4 v8, s[8:11], s38 offen offset:1024 sc1 lds
  buffer_load_dwordx4 v8, s[8:11], s38 offen offset:2048 sc1 lds
  buffer_load_dwordx4 v8, s[8:11], s38 offen offset:3072 sc1 lds
  s_add_u32 s38, s38, 4096
  s_add_u32 s40, s40, 32768
  s_waitcnt vmcnt(8)
  s_barrier
  s_add_u32 m0, s40, 0
  s_nop 0
  buffer_load_dwordx4 v8, s[8:11], s38 offen offset:0 sc1 lds
  buffer_load_dwordx4 v8, s[8:11], s38 offen offset:1024 sc1 lds
  buffer_load_dwordx4 v8, s[8:11], s38 offen offset:2048 sc1 lds
  buffer_load_dwordx4 v8, s[8:11], s38 offen offset:3072 sc1 lds
  s_add_u32 s38, s38, 4096
  s_add_u32 m0, s40, 4096
  s_nop 0
  buffer_load_dwordx4 v8, s[8:11], s38 offen offset:0 sc1 lds
  buffer_load_dwordx4 v8, s[8:11], s38 offen offset:1024 sc1 lds
  buffer_load_dwordx4 v8, s[8:11], s38 offen offset:2048 sc1 lds
  buffer_load_dwordx4 v8, s[8:11], s38 offen offset:3072 sc1 lds
  s_add_u32 s38, s38, 4096
  s_add_u32 s40, s40, 32768
  s_waitcnt vmcnt(8)
  s_barrier
  s_add_u32 m0, s40, 0
  s_nop 0
  buffer_load_dwordx4 v8, s[8:11], s38 offen offset:0 sc1 lds
  buffer_load_dwordx4 v8, s[8:11], s38 offen offset:1024 sc1 lds
  buffer_load_dwordx4 v8, s[8:11], s38 offen offset:2048 sc1 lds
  buffer_load_dwordx4 v8, s[8:11], s38 offen offset:3072 sc1 lds
  s_add_u32 s38, s38, 4096
  s_add_u32 m0, s40, 4096
  s_nop 0
  buffer_load_dwordx4 v8, s[8:11], s38 offen offset:0 sc1 lds
  buffer_load_dwordx4 v8, s[8:11], s38 offen offset:1024 sc1 lds
  buffer_load_dwordx4 v8, s[8:11], s38 offen offset:2048 sc1 lds
  buffer_load_dwordx4 v8, s[8:11], s38 offen offset:3072 sc1 lds
  s_add_u32 s38, s38, 4096
  s_add_u32 s40, s40, 32768
  s_waitcnt vmcnt(8)
  s_barrier
  s_mov_b32 s40, s39
  s_add_u32 m0, s40, 0
  s_nop 0
  buffer_load_dwordx4 v8, s[8:11], s38 offen offset:0 sc1 lds
  buffer_load_dwordx4 v8, s[8:11], s38 offen offset:1024 sc1 lds
  buffer_load_dwordx4 v8, s[8:11], s38 offen offset:2048 sc1 lds
  buffer_load_dwordx4 v8, s[8:11], s38 offen offset:3072 sc1 lds
  s_add_u32 s38, s38, 4096
  s_add_u32 m0, s40, 4096
  s_nop 0
  buffer_load_dwordx4 v8, s[8:11], s38 offen offset:0 sc1 lds
  buffer_load_dwordx4 v8, s[8:11], s38 offen offset:1024 sc1 lds
  buffer_load_dwordx4 v8, s[8:11], s38 offen offset:2048 sc1 lds
  buffer_load_dwordx4 v8, s[8:11], s38 offen offset:3072 sc1 lds
  s_add_u32 s38, s38, 4096
  s_add_u32 s40, s40, 32768
  s_waitcnt vmcnt(8)
  s_barrier
  s_add_u32 m0, s40, 0
  s_nop 0
  buffer_load_dwordx4 v8, s[8:11], s38 offen offset:0 sc1 lds
  buffer_load_dwordx4 v8, s[8:11], s38 offen offset:1024 sc1 lds
  buffer_load_dwordx4 v8, s[8:11], s38 offen offset:2048 sc1 lds
  buffer_load_dwordx4 v8, s[8:11], s38 offen offset:3072 sc1 lds
  s_add_u32 s38, s38, 4096
  s_add_u32 m0, s40, 4096
  s_nop 0
  buffer_load_dwordx4 v8, s[8:11], s38 offen offset:0 sc1 lds
  buffer_load_dwordx4 v8, s[8:11], s38 offen offset:1024 sc1 lds
  buffer_load_dwordx4 v8, s[8:11], s38 offen offset:2048 sc1 lds
  buffer_load_dwordx4 v8, s[8:11], s38 offen offset:3072 sc1 lds
  s_add_u32 s38, s38, 4096
  s_add_u32 s40, s40, 32768
  s_waitcnt vmcnt(8)
  s_barrier
  s_add_u32 m0, s40, 0
  s_nop 0
  buffer_load_dwordx4 v8, s[8:11], s38 offen offset:0 sc1 lds
  buffer_load_dwordx4 v8, s[8:11], s38 offen offset:1024 sc1 lds
  buffer_load_dwordx4 v8, s[8:11], s38 offen offset:2048 sc1 lds
  buffer_load_dwordx4 v8, s[8:11], s38 offen offset:3072 sc1 lds
  s_add_u32 s38, s38, 4096
  s_add_u32 m0, s40, 4096
  s_nop 0
  buffer_load_dwordx4 v8, s[8:11], s38 offen offset:0 sc1 lds
  buffer_load_dwordx4 v8, s[8:11], s38 offen offset:1024 sc1 lds
  s_add_u32 s38, s38, 4096
  s_add_u32 s40, s40, 32768
  s_waitcnt vmcnt(6)
  s_barrier
  s_waitcnt vmcnt(0)
  s_barrier
  s_endpgm
UT_GO:
  s_xor_b32 s47, s3, 4
  s_lshl_b32 s47, s47, 4
  s_add_u32 s47, s47, s33
  s_cmp_ge_u32 s47, 86
  s_cbranch_scc1 UT_DONE
  s_and_b32 s51, s47, 1
  s_lshr_b32 s53, s47, 1
  v_lshlrev_b32 v3, 5, v2
  s_mul_i32 s44, s53, 43691
  s_lshr_b32 s44, s44, 17
  s_mul_i32 s54, s44, 3
  s_sub_u32 s54, s53, s54
  s_lshl_b32 s54, s54, 1
  s_add_u32 s54, s54, s51
  s_lshl_b32 s54, s54, 10
  s_mul_i32 s52, s44, 196608
  s_add_u32 s52, s52, s54
  s_add_u32 s52, s52, 10485760
  s_lshl_b32 s45, s44, 8
  s_add_u32 s43, s45, 245760
  s_add_u32 s45, s45, 253952
  s_cmp_eq_u32 s44, 14
  s_cselect_b32 s44, 8, 24
  v_mov_b32 v0, 0
  s_mov_b32 s31, 0
U_PLW:
  buffer_load_dword v1, v0, s[8:11], s43 offen sc1
  s_waitcnt vmcnt(0)
  v_readfirstlane_b32 s30, v1
  s_add_u32 s31, s31, 1
  s_cmp_ge_u32 s30, s44
  s_cbranch_scc1 U_PLW_OK
  s_cmp_ge_u32 s31, 0x100000
  s_cbranch_scc1 U_PLW_OK
  s_sleep 1
  s_branch U_PLW
U_PLW_OK:
  s_mov_b32 s43, 6144
  buffer_load_dwordx4 v[16:19], v3, s[8:11], s43 offen offset:0
  buffer_load_dwordx4 v[20:23], v3, s[8:11], s43 offen offset:16
  buffer_load_dwordx4 v[24:27], v3, s[8:11], s43 offen offset:2048
  buffer_load_dwordx4 v[28:31], v3, s[8:11], s43 offen offset:2064
  s_mov_b32 s43, 18432
  buffer_load_dwordx4 v[32:35], v3, s[8:11], s43 offen offset:0
  buffer_load_dwordx4 v[36:39], v3, s[8:11], s43 offen offset:16
  buffer_load_dwordx4 v[40:43], v3, s[8:11], s43 offen offset:2048
  buffer_load_dwordx4 v[44:47], v3, s[8:11], s43 offen offset:2064
  s_mov_b32 s43, 30720
  buffer_load_dwordx4 v[48:51], v3, s[8:11], s43 offen offset:0
  buffer_load_dwordx4 v[52:55], v3, s[8:11], s43 offen offset:16
  buffer_load_dwordx4 v[56:59], v3, s[8:11], s43 offen offset:2048
  buffer_load_dwordx4 v[60:63], v3, s[8:11], s43 offen offset:2064
  s_mov_b32 s43, 43008
  buffer_load_dwordx4 v[64:67], v3, s[8:11], s43 offen offset:0
  buffer_load_dwordx4 v[68:71], v3, s[8:11], s43 offen offset:16
  buffer_load_dwordx4 v[72:75], v3, s[8:11], s43 offen offset:2048
  buffer_load_dwordx4 v[76:79], v3, s[8:11], s43 offen offset:2064
  buffer_load_dwordx4 v[128:131], v8, s[8:11], s52 offen sc1
  s_add_u32 s52, s52, 6144
  buffer_load_dwordx4 v[132:135], v8, s[8:11], s52 offen sc1
  s_add_u32 s52, s52, 6144
  buffer_load_dwordx4 v[136:139], v8, s[8:11], s52 offen sc1
  s_add_u32 s52, s52, 6144
  buffer_load_dwordx4 v[140:143], v8, s[8:11], s52 offen sc1
  s_add_u32 s52, s52, 6144
  buffer_load_dwordx4 v[144:147], v8, s[8:11], s52 offen sc1
  s_add_u32 s52, s52, 6144
  buffer_load_dwordx4 v[148:151], v8, s[8:11], s52 offen sc1
  s_add_u32 s52, s52, 6144
  buffer_load_dwordx4 v[152:155], v8, s[8:11], s52 offen sc1
  s_add_u32 s52, s52, 6144
  buffer_load_dwordx4 v[156:159], v8, s[8:11], s52 offen sc1
  s_add_u32 s52, s52, 6144
  buffer_load_dwordx4 v[160:163], v8, s[8:11], s52 offen sc1
  s_add_u32 s52, s52, 6144
  buffer_load_dwordx4 v[164:167], v8, s[8:11], s52 offen sc1
  s_add_u32 s52, s52, 6144
  buffer_load_dwordx4 v[168:171], v8, s[8:11], s52 offen sc1
  s_add_u32 s52, s52, 6144
  buffer_load_dwordx4 v[172:175], v8, s[8:11], s52 offen sc1
  s_add_u32 s52, s52, 6144
  buffer_load_dwordx4 v[176:179], v8, s[8:11], s52 offen sc1
  s_add_u32 s52, s52, 6144
  buffer_load_dwordx4 v[180:183], v8, s[8:11], s52 offen sc1
  s_add_u32 s52, s52, 6144
  buffer_load_dwordx4 v[184:187], v8, s[8:11], s52 offen sc1
  s_add_u32 s52, s52, 6144
  buffer_load_dwordx4 v[188:191], v8, s[8:11], s52 offen sc1
  s_add_u32 s52, s52, 6144
  buffer_load_dwordx4 v[192:195], v8, s[8:11], s52 offen sc1
  s_add_u32 s52, s52, 6144
  buffer_load_dwordx4 v[196:199], v8, s[8:11], s52 offen sc1
  s_add_u32 s52, s52, 6144
  buffer_load_dwordx4 v[200:203], v8, s[8:11], s52 offen sc1
  s_add_u32 s52, s52, 6144
  buffer_load_dwordx4 v[204:207], v8, s[8:11], s52 offen sc1
  s_add_u32 s52, s52, 6144
  buffer_load_dwordx4 v[208:211], v8, s[8:11], s52 offen sc1
  s_add_u32 s52, s52, 6144
  buffer_load_dwordx4 v[212:215], v8, s[8:11], s52 offen sc1
  s_add_u32 s52, s52, 6144
  buffer_load_dwordx4 v[216:219], v8, s[8:11], s52 offen sc1
  s_add_u32 s52, s52, 6144
  buffer_load_dwordx4 v[220:223], v8, s[8:11], s52 offen sc1
  s_add_u32 s52, s52, 6144
  buffer_load_dwordx4 v[224:227], v8, s[8:11], s52 offen sc1
  s_add_u32 s52, s52, 6144
  buffer_load_dwordx4 v[228:231], v8, s[8:11], s52 offen sc1
  s_add_u32 s52, s52, 6144
  buffer_load_dwordx4 v[232:235], v8, s[8:11], s52 offen sc1
  s_add_u32 s52, s52, 6144
  buffer_load_dwordx4 v[236:239], v8, s[8:11], s52 offen sc1
  s_add_u32 s52, s52, 6144
  buffer_load_dwordx4 v[240:243], v8, s[8:11], s52 offen sc1
  s_add_u32 s52, s52, 6144
  buffer_load_dwordx4 v[244:247], v8, s[8:11], s52 offen sc1
  s_add_u32 s52, s52, 6144
  buffer_load_dwordx4 v[248:251], v8, s[8:11], s52 offen sc1
  s_add_u32 s52, s52, 6144
  buffer_load_dwordx4 v[252:255], v8, s[8:11], s52 offen sc1
  s_add_u32 s52, s52, 6144
  s_lshl_b32 s43, s3, 11
  s_add_u32 s43, s43, 131072
  v_add_u32 v4, s43, v8
  v_mov_b32 v80, 0
  v_mov_b32 v81, 0
  v_mov_b32 v82, 0
  v_mov_b32 v83, 0
  v_add_u32 v5, 147456, v8
  ds_write_b128 v5, v[80:83]
  s_waitcnt vmcnt(32)
  v_add_f32 v16, v16, v32
  v_add_f32 v48, v48, v64
  v_add_f32 v16, v16, v48
  v_add_f32 v17, v17, v33
  v_add_f32 v49, v49, v65
  v_add_f32 v17, v17, v49
  v_add_f32 v18, v18, v34
  v_add_f32 v50, v50, v66
  v_add_f32 v18, v18, v50
  v_add_f32 v19, v19, v35
  v_add_f32 v51, v51, v67
  v_add_f32 v19, v19, v51
  v_add_f32 v20, v20, v36
  v_add_f32 v52, v52, v68
  v_add_f32 v20, v20, v52
  v_add_f32 v21, v21, v37
  v_add_f32 v53, v53, v69
  v_add_f32 v21, v21, v53
  v_add_f32 v22, v22, v38
  v_add_f32 v54, v54, v70
  v_add_f32 v22, v22, v54
  v_add_f32 v23, v23, v39
  v_add_f32 v55, v55, v71
  v_add_f32 v23, v23, v55
  v_add_f32 v24, v24, v40
  v_add_f32 v56, v56, v72
  v_add_f32 v24, v24, v56
  v_add_f32 v25, v25, v41
  v_add_f32 v57, v57, v73
  v_add_f32 v25, v25, v57
  v_add_f32 v26, v26, v42
  v_add_f32 v58, v58, v74
  v_add_f32 v26, v26, v58
  v_add_f32 v27, v27, v43
  v_add_f32 v59, v59, v75
  v_add_f32 v27, v27, v59
  v_add_f32 v28, v28, v44
  v_add_f32 v60, v60, v76
  v_add_f32 v28, v28, v60
  v_add_f32 v29, v29, v45
  v_add_f32 v61, v61, v77
  v_add_f32 v29, v29, v61
  v_add_f32 v30, v30, v46
  v_add_f32 v62, v62, v78
  v_add_f32 v30, v30, v62
  v_add_f32 v31, v31, v47
  v_add_f32 v63, v63, v79
  v_add_f32 v31, v31, v63
  v_cvt_pk_bf16_f32 v84, v16, v17
  v_cvt_pk_bf16_f32 v85, v18, v19
  v_cvt_pk_bf16_f32 v86, v20, v21
  v_cvt_pk_bf16_f32 v87, v22, v23
  v_cvt_pk_bf16_f32 v1, v24, v25
  v_lshlrev_b32 v24, 16, v1
  v_and_b32 v25, 0xffff0000, v1
  v_add_f32 v24, 1.0, v24
  v_add_f32 v25, 1.0, v25
  v_cvt_pk_bf16_f32 v88, v24, v25
  v_cvt_pk_bf16_f32 v1, v26, v27
  v_lshlrev_b32 v26, 16, v1
  v_and_b32 v27, 0xffff0000, v1
  v_add_f32 v26, 1.0, v26
  v_add_f32 v27, 1.0, v27
  v_cvt_pk_bf16_f32 v89, v26, v27
  v_cvt_pk_bf16_f32 v1, v28, v29
  v_lshlrev_b32 v28, 16, v1
  v_and_b32 v29, 0xffff0000, v1
  v_add_f32 v28, 1.0, v28
  v_add_f32 v29, 1.0, v29
  v_cvt_pk_bf16_f32 v90, v28, v29
  v_cvt_pk_bf16_f32 v1, v30, v31
  v_lshlrev_b32 v30, 16, v1
  v_and_b32 v31, 0xffff0000, v1
  v_add_f32 v30, 1.0, v30
  v_add_f32 v31, 1.0, v31
  v_cvt_pk_bf16_f32 v91, v30, v31
  ds_write_b128 v4, v[88:91]
  ds_write_b128 v4, v[84:87] offset:1024
  v_and_b32 v3, 31, v2
  v_lshrrev_b32 v6, 5, v2
  v_lshlrev_b32 v7, 10, v3
  v_add_u32 v7, s43, v7
  v_mov_b32 v5, 147456
  v_cmp_gt_u32 vcc, 2, v3
  s_nop 1
  v_cndmask_b32 v7, v5, v7, vcc
  v_lshl_add_u32 v7, v6, 3, v7
  s_waitcnt lgkmcnt(0)
  ds_read_b64 v[16:17], v7 offset:0
  ds_read_b64 v[18:19], v7 offset:16
  ds_read_b64 v[20:21], v7 offset:32
  ds_read_b64 v[22:23], v7 offset:48
  ds_read_b64 v[24:25], v7 offset:64
  ds_read_b64 v[26:27], v7 offset:80
  ds_read_b64 v[28:29], v7 offset:96
  ds_read_b64 v[30:31], v7 offset:112
  ds_read_b64 v[32:33], v7 offset:128
  ds_read_b64 v[34:35], v7 offset:144
  ds_read_b64 v[36:37], v7 offset:160
  ds_read_b64 v[38:39], v7 offset:176
  ds_read_b64 v[40:41], v7 offset:192
  ds_read_b64 v[42:43], v7 offset:208
  ds_read_b64 v[44:45], v7 offset:224
  ds_read_b64 v[46:47], v7 offset:240
  s_waitcnt vmcnt(24) lgkmcnt(0)
  v_mfma_f32_32x32x16_bf16 v[48:63], v[128:131], v[16:19], 0
  v_mfma_f32_32x32x16_bf16 v[48:63], v[132:135], v[20:23], v[48:63]
  v_mfma_f32_32x32x16_bf16 v[48:63], v[136:139], v[24:27], v[48:63]
  v_mfma_f32_32x32x16_bf16 v[48:63], v[140:143], v[28:31], v[48:63]
  v_mfma_f32_32x32x16_bf16 v[48:63], v[144:147], v[32:35], v[48:63]
  v_mfma_f32_32x32x16_bf16 v[48:63], v[148:151], v[36:39], v[48:63]
  v_mfma_f32_32x32x16_bf16 v[48:63], v[152:155], v[40:43], v[48:63]
  v_mfma_f32_32x32x16_bf16 v[48:63], v[156:159], v[44:47], v[48:63]
  s_nop 7
  ds_read_b64 v[16:17], v7 offset:256
  ds_read_b64 v[18:19], v7 offset:272
  ds_read_b64 v[20:21], v7 offset:288
  ds_read_b64 v[22:23], v7 offset:304
  ds_read_b64 v[24:25], v7 offset:320
  ds_read_b64 v[26:27], v7 offset:336
  ds_read_b64 v[28:29], v7 offset:352
  ds_read_b64 v[30:31], v7 offset:368
  ds_read_b64 v[32:33], v7 offset:384
  ds_read_b64 v[34:35], v7 offset:400
  ds_read_b64 v[36:37], v7 offset:416
  ds_read_b64 v[38:39], v7 offset:432
  ds_read_b64 v[40:41], v7 offset:448
  ds_read_b64 v[42:43], v7 offset:464
  ds_read_b64 v[44:45], v7 offset:480
  ds_read_b64 v[46:47], v7 offset:496
  s_waitcnt vmcnt(16) lgkmcnt(0)
  v_mfma_f32_32x32x16_bf16 v[48:63], v[160:163], v[16:19], v[48:63]
  v_mfma_f32_32x32x16_bf16 v[48:63], v[164:167], v[20:23], v[48:63]
  v_mfma_f32_32x32x16_bf16 v[48:63], v[168:171], v[24:27], v[48:63]
  v_mfma_f32_32x32x16_bf16 v[48:63], v[172:175], v[28:31], v[48:63]
  v_mfma_f32_32x32x16_bf16 v[48:63], v[176:179], v[32:35], v[48:63]
  v_mfma_f32_32x32x16_bf16 v[48:63], v[180:183], v[36:39], v[48:63]
  v_mfma_f32_32x32x16_bf16 v[48:63], v[184:187], v[40:43], v[48:63]
  v_mfma_f32_32x32x16_bf16 v[48:63], v[188:191], v[44:47], v[48:63]
  s_nop 7
  ds_read_b64 v[16:17], v7 offset:512
  ds_read_b64 v[18:19], v7 offset:528
  ds_read_b64 v[20:21], v7 offset:544
  ds_read_b64 v[22:23], v7 offset:560
  ds_read_b64 v[24:25], v7 offset:576
  ds_read_b64 v[26:27], v7 offset:592
  ds_read_b64 v[28:29], v7 offset:608
  ds_read_b64 v[30:31], v7 offset:624
  ds_read_b64 v[32:33], v7 offset:640
  ds_read_b64 v[34:35], v7 offset:656
  ds_read_b64 v[36:37], v7 offset:672
  ds_read_b64 v[38:39], v7 offset:688
  ds_read_b64 v[40:41], v7 offset:704
  ds_read_b64 v[42:43], v7 offset:720
  ds_read_b64 v[44:45], v7 offset:736
  ds_read_b64 v[46:47], v7 offset:752
  s_waitcnt vmcnt(8) lgkmcnt(0)
  v_mfma_f32_32x32x16_bf16 v[48:63], v[192:195], v[16:19], v[48:63]
  v_mfma_f32_32x32x16_bf16 v[48:63], v[196:199], v[20:23], v[48:63]
  v_mfma_f32_32x32x16_bf16 v[48:63], v[200:203], v[24:27], v[48:63]
  v_mfma_f32_32x32x16_bf16 v[48:63], v[204:207], v[28:31], v[48:63]
  v_mfma_f32_32x32x16_bf16 v[48:63], v[208:211], v[32:35], v[48:63]
  v_mfma_f32_32x32x16_bf16 v[48:63], v[212:215], v[36:39], v[48:63]
  v_mfma_f32_32x32x16_bf16 v[48:63], v[216:219], v[40:43], v[48:63]
  v_mfma_f32_32x32x16_bf16 v[48:63], v[220:223], v[44:47], v[48:63]
  s_nop 7
  ds_read_b64 v[16:17], v7 offset:768
  ds_read_b64 v[18:19], v7 offset:784
  ds_read_b64 v[20:21], v7 offset:800
  ds_read_b64 v[22:23], v7 offset:816
  ds_read_b64 v[24:25], v7 offset:832
  ds_read_b64 v[26:27], v7 offset:848
  ds_read_b64 v[28:29], v7 offset:864
  ds_read_b64 v[30:31], v7 offset:880
  ds_read_b64 v[32:33], v7 offset:896
  ds_read_b64 v[34:35], v7 offset:912
  ds_read_b64 v[36:37], v7 offset:928
  ds_read_b64 v[38:39], v7 offset:944
  ds_read_b64 v[40:41], v7 offset:960
  ds_read_b64 v[42:43], v7 offset:976
  ds_read_b64 v[44:45], v7 offset:992
  ds_read_b64 v[46:47], v7 offset:1008
  s_waitcnt vmcnt(0) lgkmcnt(0)
  v_mfma_f32_32x32x16_bf16 v[48:63], v[224:227], v[16:19], v[48:63]
  v_mfma_f32_32x32x16_bf16 v[48:63], v[228:231], v[20:23], v[48:63]
  v_mfma_f32_32x32x16_bf16 v[48:63], v[232:235], v[24:27], v[48:63]
  v_mfma_f32_32x32x16_bf16 v[48:63], v[236:239], v[28:31], v[48:63]
  v_mfma_f32_32x32x16_bf16 v[48:63], v[240:243], v[32:35], v[48:63]
  v_mfma_f32_32x32x16_bf16 v[48:63], v[244:247], v[36:39], v[48:63]
  v_mfma_f32_32x32x16_bf16 v[48:63], v[248:251], v[40:43], v[48:63]
  v_mfma_f32_32x32x16_bf16 v[48:63], v[252:255], v[44:47], v[48:63]
  s_nop 7
  v_mul_u32_u24 v4, 5632, v3
  v_lshl_add_u32 v4, v6, 4, v4
  v_mov_b32 v5, 0x7ff00000
  v_cndmask_b32 v4, v5, v4, vcc
  s_mul_i32 s52, s51, 11264
  s_lshl_b32 s54, s53, 7
  s_add_u32 s52, s52, s54
  s_add_u32 s52, s52, 81920
  s_nop 7
  buffer_store_dwordx4 v[48:51], v4, s[8:11], s52 offen offset:0 sc1
  buffer_store_dwordx4 v[52:55], v4, s[8:11], s52 offen offset:32 sc1
  buffer_store_dwordx4 v[56:59], v4, s[8:11], s52 offen offset:64 sc1
  buffer_store_dwordx4 v[60:63], v4, s[8:11], s52 offen offset:96 sc1
  s_waitcnt vmcnt(0)
  v_mov_b32 v0, 0
  v_mov_b32 v1, 1
  s_mov_b64 exec, 1
  buffer_atomic_add v1, v0, s[8:11], s45 offen sc1
  s_mov_b64 exec, -1
UT_DONE:
  s_cmp_ge_u32 s3, 4
  s_cbranch_scc1 L_P4
  s_branch C_P4
KM_END:
  s_endpgm
.section .rodata,"a"
.p2align 6
.amdhsa_kernel k0_kernel
  .amdhsa_next_free_vgpr 128
  .amdhsa_next_free_sgpr 96
  .amdhsa_accum_offset 128
  .amdhsa_group_segment_fixed_size 0
  .amdhsa_kernarg_size 96
  .amdhsa_user_sgpr_count 2
  .amdhsa_user_sgpr_kernarg_segment_ptr 1
  .amdhsa_system_sgpr_workgroup_id_x 1
.end_amdhsa_kernel
.p2align 6
.amdhsa_kernel km_kernel
  .amdhsa_next_free_vgpr 256
  .amdhsa_next_free_sgpr 96
  .amdhsa_accum_offset 256
  .amdhsa_group_segment_fixed_size 0
  .amdhsa_kernarg_size 96
  .amdhsa_user_sgpr_count 2
  .amdhsa_user_sgpr_kernarg_segment_ptr 1
  .amdhsa_system_sgpr_workgroup_id_x 1
.end_amdhsa_kernel
```
